```python
import torch

def _softmax(x, axis=-1):
    return torch.softmax(x, dim=axis)
def _gelu(x):
    return torch.nn.functional.gelu(x, approximate="tanh")
def _silu(x):
    return torch.nn.functional.silu(x)
def _sigmoid(x):
    return torch.sigmoid(x)
def _layernorm(x, axis=-1, eps=1e-5):
    m = x.mean(dim=axis, keepdim=True)
    v = x.var(dim=axis, keepdim=True, unbiased=False)
    return (x - m) / torch.sqrt(v + eps)
def _scatter_add(tgt, idx, src, axis=0):
    return tgt.clone().index_add_(axis, idx, src)
def _segment_sum(src, seg, n):
    out = torch.zeros((n,) + src.shape[1:], dtype=src.dtype)
    return out.index_add_(0, seg, src)
def _pad(x, pw):
    flat = tuple(v for pair in reversed(pw) for v in pair)
    return torch.nn.functional.pad(x, flat)

kernel_name = 'recurrent_scan__ssm_conv_s4d__moe_arch_mod__prompt'

def setup_inputs():

    _w = (lambda a: (lambda t: t.to(torch.bfloat16) if t.is_floating_point() else t)(torch.as_tensor(a)))
    def _A_setup():
        Bsz, L, D, N = 1, 2048, 512, 128
        return {
            "u": _w((lambda *s: torch.randn(*s, dtype=torch.bfloat16) * 0.05)(Bsz, L, D)),
            "log_A_real": _w((lambda *s: torch.randn(*s, dtype=torch.bfloat16) * 3.2)(D, N) * 0.5),
            "A_imag": _w((lambda *s: torch.randn(*s, dtype=torch.bfloat16) * 0.05)(D, N) * 3.14),
            "C_real": _w((lambda *s: torch.randn(*s, dtype=torch.bfloat16) * 0.1)(D, N) / N ** 0.5),
            "C_imag": _w((lambda *s: torch.randn(*s, dtype=torch.bfloat16) * 0.1)(D, N) / N ** 0.5),
            "log_dt": _w((lambda *s: torch.randn(*s, dtype=torch.bfloat16) * 0.05)(D) * 0.5 - 4.0),
            "D_skip": _w((lambda *s: torch.randn(*s, dtype=torch.bfloat16) * 0.05)(D)),
        }
    _A_in = _A_setup()

    def _B_setup():
        B, S, D, F, C = 1, 2048, 512, 1376, 2
        return {
            "x": _w((lambda *s: torch.randn(*s, dtype=torch.bfloat16) * 0.05)(B, S, D)),
            "w_r": _w((lambda *s: torch.randn(*s, dtype=torch.bfloat16) * 3.2)(D)),
            "w_gate": _w((lambda *s: torch.randn(*s, dtype=torch.bfloat16) * 0.1)(D, F)),
            "w_up": _w((lambda *s: torch.randn(*s, dtype=torch.bfloat16) * 0.1)(D, F)),
            "w_down": _w((lambda *s: torch.randn(*s, dtype=torch.bfloat16) * 0.1)(F, D)),
        }
    _B_in = _B_setup()

    return {
        "A_u": _A_in["u"],
        "A_log_A_real": _A_in["log_A_real"],
        "A_A_imag": _A_in["A_imag"],
        "A_C_real": _A_in["C_real"],
        "A_C_imag": _A_in["C_imag"],
        "A_log_dt": _A_in["log_dt"],
        "A_D_skip": _A_in["D_skip"],
        "B_x": _B_in["x"],
        "B_w_r": _B_in["w_r"],
        "B_w_gate": _B_in["w_gate"],
        "B_w_up": _B_in["w_up"],
        "B_w_down": _B_in["w_down"],
    }

def reference(A_u, A_log_A_real, A_A_imag, A_C_real, A_C_imag, A_log_dt, A_D_skip, B_x, B_w_r, B_w_gate, B_w_up, B_w_down):
    def _A_ref(u, log_A_real, A_imag, C_real, C_imag, log_dt, D_skip):
        L = u.shape[1]
        dt = torch.exp(log_dt)
        A = -torch.exp(log_A_real) + 1j * A_imag
        C = (C_real + 1j * C_imag) * dt[:, None]
        pos = (lambda x, dt: x.to(dt))(torch.arange(L), log_dt.dtype)
        P = torch.exp((A * dt[:, None])[:, :, None] * pos[None, None, :])
        K = 2.0 * torch.einsum("dn,dnl->dl", C, P).real
        L2 = 2 * L
        u_t = (lambda x, *d: x.permute(*d))(u, 0, 2, 1)
        Kf = (lambda x, *a, **k: torch.fft.rfft(x.float(), *a, **k))(K, L2)
        Uf = (lambda x, *a, **k: torch.fft.rfft(x.float(), *a, **k))(u_t, L2)
        y = (lambda x, *a, **k: torch.fft.irfft(x, *a, **k).to(torch.bfloat16))(Uf * Kf[None, :, :], L2)[:, :, :L]
        y = (lambda x, *d: x.permute(*d))(y, 0, 2, 1)
        return y + u * D_skip[None, None, :]

    def _B_ref(x, w_r, w_gate, w_up, w_down):
        B, S, D = x.shape
        C = 2
        r = x @ w_r
        idx = torch.argsort(-r, axis=-1)[:, :C]
        idx_e = (lambda x, n, axis: torch.repeat_interleave(x, n, dim=axis))(idx.reshape(B, C, 1), D, axis=2)
        x_sel = (lambda x, i, axis: torch.take_along_dim(x, i, dim=axis))(x, idx_e, axis=1)
        g = _silu(x_sel @ w_gate)
        u = x_sel @ w_up
        y = (g * u) @ w_down
        r_sel = _sigmoid((lambda x, i, axis: torch.take_along_dim(x, i, dim=axis))(r, idx, axis=1))
        y = y * r_sel.reshape(B, C, 1)
        b_off = (torch.arange(B) * S).reshape(B, 1)
        flat_idx = (idx + b_off).reshape(B * C)
        zero = (x * 0.0).reshape(B * S, D)
        upd = _scatter_add(zero, flat_idx, y.reshape(B * C, D), axis=0)
        return x + upd.reshape(B, S, D)

    x = A_u
    xn = _layernorm(x, axis=-1)
    s = _A_ref(xn, A_log_A_real, A_A_imag, A_C_real, A_C_imag, A_log_dt, A_D_skip)
    g = _silu(_B_ref(xn, B_w_r, B_w_gate, B_w_up, B_w_down))
    return x + s * g
```

```asm
; @launch grid=(256,1,1) block=(768,1,1) lds=145200
.amdgcn_target "amdgcn-amd-amdhsa--gfx950"
.text
.globl recurrent_scan__ssm_conv_s4d__moe_arch_mod__prompt_kernel
.p2align 8
.type recurrent_scan__ssm_conv_s4d__moe_arch_mod__prompt_kernel,@function
recurrent_scan__ssm_conv_s4d__moe_arch_mod__prompt_kernel:
    s_cmp_ge_u32 s2, 256
    s_cbranch_scc1 L_END
    v_lshrrev_b32 v1, 6, v0
    v_and_b32 v0, 63, v0
    v_readfirstlane_b32 s4, v1
    s_lshr_b32 s6, s2, 3
    s_and_b32 s5, s2, 7
    s_lshl_b32 s7, s5, 5
    s_add_u32 s7, s7, s6
    s_load_dwordx2 s[12:13], s[0:1], 112
    s_cmp_ge_u32 s4, 8
    s_cbranch_scc1 L_P_M
    s_load_dwordx16 s[32:47], s[0:1], 0
    s_load_dwordx8 s[48:55], s[0:1], 64
    s_load_dwordx2 s[56:57], s[0:1], 96
    v_lshlrev_b32 v1, 4, v0
    s_cmp_ge_u32 s4, 4
    s_cbranch_scc1 L_P_EF
    v_min_u32 v6, 304, v1
    v_add_u32 v6, 144320, v6
    v_mov_b32 v24, 0
    v_mov_b32 v25, 0
    v_mov_b32 v26, 0
    v_mov_b32 v27, 0
    ds_write_b128 v6, v[24:27]
    v_and_b32 v2, 0x1f0, v1
    v_and_b32 v3, 0x200, v1
    s_lshl_b32 s11, s2, 13
    s_lshl_b32 s10, s4, 11
    s_add_u32 s10, s10, s11
    v_add3_u32 v3, v3, v1, s10
    s_waitcnt lgkmcnt(0)
    global_load_dwordx4 v[8:11], v3, s[32:33]
    global_load_dwordx4 v[12:15], v3, s[32:33] offset:512
    global_load_dwordx4 v[16:19], v2, s[48:49]
    global_load_dwordx4 v[20:23], v2, s[48:49] offset:512
    s_barrier
    s_branch L_P_E2
L_P_M:
    v_mov_b32 v10, 0
    global_load_dwordx4 v[12:15], v10, s[0:1] offset:8
    global_load_dwordx4 v[16:19], v10, s[0:1] offset:24
    global_load_dwordx2 v[20:21], v10, s[0:1] offset:40
    s_sub_u32 s4, s4, 8
    s_getpc_b64 s[64:65]
L_PCREF:
    s_cmp_eq_u32 s4, 3
    s_cbranch_scc1 L_P_M3
    s_mul_i32 s68, s6, 3
    s_add_u32 s68, s68, s4
    s_lshl_b32 s68, s68, 8
    v_and_b32 v24, 1, v0
    v_lshl_add_u32 v24, v24, 7, s68
    v_min_u32 v24, L_CODE_END - L_PCREF - 4, v24
    v_mov_b32 v25, 0
    v_lshl_add_u64 v[24:25], v[24:25], 0, s[64:65]
    global_load_dword v162, v[24:25], off
    s_branch L_P_M4
L_P_M3:
    s_waitcnt lgkmcnt(0)
    s_load_dword s8, s[12:13], 0
    s_waitcnt vmcnt(0)
L_P_M4:
    s_lshr_b32 s60, s4, 1
    s_lshl_b32 s10, s7, 1
    s_add_u32 s10, s10, s60
    s_lshl_b32 s11, s10, 8
    v_lshl_add_u32 v8, v0, 2, s11
    v_mov_b32 v9, 0
    s_lshl_b32 s10, s10, 1
    s_mov_b32 s11, 0
    s_waitcnt vmcnt(1)
    v_lshl_add_u64 v[20:21], v[20:21], 0, s[10:11]
    v_lshl_add_u64 v[12:13], v[12:13], 0, v[8:9]
    v_lshl_add_u64 v[14:15], v[14:15], 0, v[8:9]
    global_load_ushort v3, v[20:21], off
    global_load_dword v4, v[12:13], off
    global_load_dword v5, v[14:15], off
    v_lshl_add_u64 v[16:17], v[16:17], 0, v[8:9]
    v_lshl_add_u64 v[18:19], v[18:19], 0, v[8:9]
    global_load_dword v6, v[16:17], off
    global_load_dword v7, v[18:19], off
    s_cmp_lg_u32 s4, 3
    s_barrier
    s_cbranch_scc1 L_M
    v_mov_b32 v60, 144556
    s_waitcnt lgkmcnt(0)
    s_mul_i32 s8, s8, 0x9E3779B1
    s_add_u32 s8, s8, 0x7F4A7C15
    s_or_b32 s8, s8, 0x100
    v_mov_b32 v61, s8
    ds_write_b32 v60, v61
    s_branch L_M
L_P_EF:
    s_sub_u32 s61, s4, 4
    v_and_b32 v4, 0x380, v1
    v_and_b32 v5, 0x70, v1
    s_lshl_b32 s10, s6, 16
    s_lshl_b32 s11, s61, 14
    v_lshl_add_u32 v4, v4, 3, v5
    s_add_u32 s10, s10, s11
    s_lshl_b32 s11, s5, 7
    s_add_u32 s10, s10, s11
    s_lshl_b32 s62, s61, 11
    s_lshl_b32 s68, s7, 13
    s_add_u32 s68, s68, s62
    s_add_u32 s68, s68, 0x200000
    s_add_u32 s62, s62, 131520
    s_mov_b32 m0, s62
    v_add_u32 v4, s10, v4
    v_add_u32 v5, 7168, v4
    v_and_b32 v60, 15, v0
    v_lshl_add_u32 v60, v60, 7, s68
    s_lshl_b32 s68, s5, 9
    s_lshl_b32 s69, s61, 7
    s_add_u32 s68, s68, s69
    s_add_u32 s68, s68, 0x8000
    v_writelane_b32 v60, s68, 16
    s_lshl_b32 s68, s7, 9
    s_add_u32 s68, s68, s69
    s_add_u32 s68, s68, 0x80000
    v_writelane_b32 v60, s68, 17
    s_lshr_b32 s68, s7, 2
    s_lshl_b32 s68, s68, 7
    s_add_u32 s68, s68, 0xa000
    v_writelane_b32 v60, s68, 18
    s_lshl_b32 s68, s2, 10
    s_lshl_b32 s69, s61, 8
    s_add_u32 s68, s68, s69
    s_add_u32 s68, s68, 0x40000
    v_writelane_b32 v60, s68, 19
    s_add_u32 s68, s68, 128
    v_writelane_b32 v60, s68, 20
    s_waitcnt lgkmcnt(0)
    global_load_lds_dwordx4 v4, s[32:33]
    global_load_lds_dwordx4 v5, s[32:33] offset:1024
    s_barrier
    global_load_dword v167, v60, s[12:13] nt
L_P_E2:
    s_lshl_b32 s58, s7, 2
    s_load_dword s59, s[44:45], s58
    s_mov_b32 s14, 0x1000000
    s_mov_b32 s15, 0x00020000
    s_mov_b32 s3, 1000000
    s_mov_b32 s9, 0xffff0000
    v_mov_b32 v165, 1
    s_xor_b32 s63, s4, 4
    s_mov_b32 s16, s32
    s_mov_b32 s17, s33
    s_mov_b32 s18, 0x200000
    s_mov_b32 s19, 0x00020000
    s_mov_b32 s23, 0x00020000
    s_mov_b32 s27, 0x00020000
    v_lshlrev_b32 v164, 2, v0
    v_add_u32 v164, 144624, v164
    s_getreg_b32 s74, hwreg(HW_REG_XCC_ID, 0, 4)
    v_mov_b32 v37, 144544
    v_mov_b32 v36, 0
    s_cmp_ge_u32 s4, 4
    s_cbranch_scc1 L_EF
    s_lshl_b32 s24, s2, 3
    s_lshl_b32 s25, s4, 1
    s_add_u32 s24, s24, s25
    s_lshr_b32 s25, s24, 8
    s_lshl_b32 s25, s25, 11
    s_and_b32 s26, s4, 1
    s_lshl_b32 s26, s26, 10
    s_add_u32 s25, s25, s26
    s_bfe_u32 s26, s24, 0x60002
    s_lshl_b32 s26, s26, 4
    s_add_u32 s25, s25, s26
    s_add_u32 s25, s25, 0x10000
    s_mov_b32 s28, 0x3f803f80
    v_mov_b32 v28, 0x3b000000
    v_lshrrev_b32 v29, 5, v0
    s_sub_u32 s26, 2047, s24
    v_sub_u32 v29, s26, v29
    v_mov_b32 v34, 0
    s_lshl_b32 s29, s2, 4
    s_add_u32 s29, s29, 0x14000
    s_mov_b32 s30, 1
    s_mov_b32 s31, 1
    s_setprio 3
    s_waitcnt vmcnt(2)
    v_dot2c_f32_bf16 v24, s28, v8
    v_dot2c_f32_bf16 v25, v8, v8
    v_dot2c_f32_bf16 v24, s28, v9
    v_dot2c_f32_bf16 v25, v9, v9
    v_dot2c_f32_bf16 v24, s28, v10
    v_dot2c_f32_bf16 v25, v10, v10
    v_dot2c_f32_bf16 v24, s28, v11
    v_dot2c_f32_bf16 v25, v11, v11
    v_dot2c_f32_bf16 v24, s28, v12
    v_dot2c_f32_bf16 v25, v12, v12
    v_dot2c_f32_bf16 v24, s28, v13
    v_dot2c_f32_bf16 v25, v13, v13
    v_dot2c_f32_bf16 v24, s28, v14
    v_dot2c_f32_bf16 v25, v14, v14
    v_dot2c_f32_bf16 v24, s28, v15
    v_dot2c_f32_bf16 v25, v15, v15
    s_waitcnt vmcnt(0)
    v_dot2c_f32_bf16 v26, v8, v16
    v_dot2c_f32_bf16 v27, s28, v16
    v_dot2c_f32_bf16 v26, v9, v17
    v_dot2c_f32_bf16 v27, s28, v17
    v_dot2c_f32_bf16 v26, v10, v18
    v_dot2c_f32_bf16 v27, s28, v18
    v_dot2c_f32_bf16 v26, v11, v19
    v_dot2c_f32_bf16 v27, s28, v19
    v_dot2c_f32_bf16 v26, v12, v20
    v_dot2c_f32_bf16 v27, s28, v20
    v_dot2c_f32_bf16 v26, v13, v21
    v_dot2c_f32_bf16 v27, s28, v21
    v_dot2c_f32_bf16 v26, v14, v22
    v_dot2c_f32_bf16 v27, s28, v22
    v_dot2c_f32_bf16 v26, v15, v23
    v_dot2c_f32_bf16 v27, s28, v23
    v_permlane16_swap_b32 v24, v25
    s_nop 1
    v_add_f32 v24, v24, v25
    v_permlane16_swap_b32 v26, v27
    s_nop 0
    v_add_f32_dpp v24, v24, v24 row_ror:8 row_mask:0xf bank_mask:0xf
    v_add_f32 v26, v26, v27
    s_nop 0
    v_add_f32_dpp v24, v24, v24 row_ror:4 row_mask:0xf bank_mask:0xf
    v_add_f32_dpp v26, v26, v26 row_ror:8 row_mask:0xf bank_mask:0xf
    s_nop 0
    v_add_f32_dpp v24, v24, v24 row_ror:2 row_mask:0xf bank_mask:0xf
    v_add_f32_dpp v26, v26, v26 row_ror:4 row_mask:0xf bank_mask:0xf
    s_nop 0
    v_add_f32_dpp v24, v24, v24 row_ror:1 row_mask:0xf bank_mask:0xf
    v_add_f32_dpp v26, v26, v26 row_ror:2 row_mask:0xf bank_mask:0xf
    v_mov_b32 v25, v24
    s_nop 0
    v_add_f32_dpp v56, v26, v26 row_ror:1 row_mask:0xf bank_mask:0xf
    v_permlane16_swap_b32 v24, v25
    v_mov_b32 v57, v56
    v_mul_f32 v24, v24, v28
    v_mul_f32 v25, v25, v28
    v_permlane16_swap_b32 v56, v57
    v_fma_f32 v26, -v24, v24, v25
    v_mul_f32 v25, 0x3b800000, v25
    v_cmp_lt_f32 vcc, v26, v25
    s_cbranch_vccnz L_EL_SLOWVAR
L_EL_VAROK:
    v_cvt_pk_bf16_f32 v27, v24, v26
    v_and_b32 v26, s9, v27
    v_add_f32 v26, 0x3727c5ac, v26
    v_lshlrev_b32 v30, 16, v27
    v_cvt_pk_bf16_f32 v26, v26, v26
    v_lshlrev_b32 v26, 16, v26
    v_sqrt_f32 v26, v26
    v_fma_f32 v56, -v30, v57, v56
    v_cvt_pk_bf16_f32 v32, v30, v26
    v_and_b32 v26, s9, v32
    v_readlane_b32 s26, v32, 32
    v_rcp_f32 v38, v26
    ds_read_b32 v35, v37 offset:12
    v_mov_b32 v33, s26
    v_mul_f32 v24, v56, v38
    v_cvt_pk_bf16_f32 v24, v24, v24
    v_ashrrev_i32 v25, 31, v24
    v_or_b32 v25, 0x80000000, v25
    v_xor_b32 v24, v24, v25
    v_and_or_b32 v24, v24, s9, v29
    s_mov_b64 exec, s[30:31]
    ds_max_rtn_u32 v25, v37, v24
    s_waitcnt lgkmcnt(0)
    v_min_u32 v25, v25, v24
    ds_max_u32 v37, v25 offset:4
    s_mov_b64 exec, 1
    v_cmp_eq_u32 vcc, 0, v35
    s_cbranch_vccnz L_EL_TAGW
L_EL_TAGOK:
    buffer_store_dwordx4 v[32:35], v36, s[12:15], s25 offen sc1
    ds_add_rtn_u32 v25, v37, v165 offset:8
    ds_read_b64 v[40:41], v37
    v_readfirstlane_b32 s8, v35
    v_mov_b32 v42, v35
    v_mov_b32 v43, s74
    s_waitcnt lgkmcnt(0)
    v_cmp_eq_u32 vcc, 3, v25
    s_cbranch_vccz L_EL_NOKEY
    buffer_store_dwordx4 v[40:43], v36, s[12:15], s29 offen sc1
    ds_add_u32 v37, v165 offset:8
L_EL_NOKEY:
    s_mov_b64 exec, -1
    s_setprio 1
    s_cmp_eq_u32 s4, 3
    s_cbranch_scc1 L_F0
L_E_X:
    s_mov_b32 s4, s63
    s_mov_b32 s63, 0
    s_lshl_b32 s75, s7, 13
    s_lshl_b32 s10, s4, 10
    s_add_u32 s75, s75, s10
    s_add_u32 s75, s75, 0x200000
    s_lshl_b32 s10, s5, 9
    s_lshl_b32 s11, s4, 6
    s_add_u32 s10, s10, s11
    s_add_u32 s10, s10, 0x8000
    v_lshlrev_b32 v76, 12, v0
    s_lshl_b32 s30, s4, 18
    s_add_u32 s30, s30, s58
    s_add_u32 s33, s30, 0x40000
    s_lshl_b32 s11, s4, 11
    s_add_u32 s11, s11, 0x10000
    s_mov_b32 s28, 100
    s_lshl_b32 s26, s4, 2
    s_add_u32 s26, s26, 144320
    v_writelane_b32 v164, s26, 0
    v_add_u32 v139, 140224, v1
    s_cmp_lt_u32 s4, 4
    s_cbranch_scc1 L_EF_T
L_E_X3:
    s_xor_b32 s74, s74, s8
    s_cmp_eq_u32 s4, 6
    s_cbranch_scc1 L_E2_X
L_E1_X:
    v_and_b32 v2, 15, v0
    v_lshlrev_b32 v2, 2, v2
    v_and_b32 v7, 3, v0
    v_lshlrev_b32 v7, 2, v7
L_E1_XP:
    s_sub_u32 s28, s28, 1
    s_cbranch_scc1 L_E1_XG
    buffer_load_dword v4, v2, s[12:15], s10 offen sc1
    s_waitcnt vmcnt(0)
    v_cmp_ne_u32 vcc, s74, v4
    s_cbranch_vccnz L_E1_XP
    buffer_load_dwordx4 v[20:23], v1, s[12:15], s75 offen offset:0 sc1
L_E1_X2:
    buffer_load_dwordx4 v[12:15], v1, s[12:15], s11 offen offset:0 sc1
    buffer_load_dwordx4 v[16:19], v1, s[12:15], s11 offen offset:1024 sc1
    s_lshl_b32 s24, s4, 9
    v_lshl_add_u32 v3, v0, 3, s24
    s_and_b32 s66, s7, 252
    s_lshl_b32 s34, s66, 5
    s_lshl_b32 s35, s4, 4
    s_add_u32 s34, s34, s35
    s_add_u32 s34, s34, 0xa000
    s_and_b32 s64, s6, 3
    s_lshl_b32 s35, s64, 2
    s_add_u32 s35, s35, s34
    v_mov_b32 v72, -1
    v_mov_b32 v73, -1
    v_mov_b32 v74, -1
    v_mov_b32 v75, -1
    v_mov_b32 v166, s8
    v_mov_b32 v148, 144584
    v_and_b32 v152, 15, v0
    v_lshrrev_b32 v153, 4, v0
    v_lshl_add_u32 v154, v152, 1, v153
    s_add_u32 s41, s24, 480
    v_lshl_add_u32 v136, v154, 4, s41
    v_lshl_add_u32 v154, v152, 2, v153
    v_lshrrev_b32 v152, 2, v152
    v_add_u32 v154, v154, v152
    s_mul_i32 s41, s4, 544
    s_add_u32 s41, s41, 22560
    v_lshl_add_u32 v137, v154, 3, s41
    s_max_u32 s41, s4, 1
    s_lshl_b32 s41, s41, 2
    s_add_u32 s41, s41, 144444
    v_mov_b32 v138, s41
L_E1_BP:
    s_sub_u32 s3, s3, 1
    s_cbranch_scc1 L_END
    ds_read_b32 v4, v148
    ds_read_b128 v[120:123], v139 offset:0
    ds_read_b128 v[124:127], v139 offset:1024
    ds_read_b128 v[128:131], v139 offset:2048
    ds_read_b128 v[132:135], v139 offset:3072
    s_waitcnt lgkmcnt(0)
    v_cmp_eq_u32 vcc, 0, v4
    s_cbranch_vccnz L_E1_BP
    s_setprio 3
L_E1_S2:
    s_waitcnt vmcnt(0)
    v_xor_b32 v15, s8, v15
    v_xor_b32 v19, s8, v19
    v_or_b32 v15, v15, v19
    v_cmp_ne_u32 vcc, 0, v15
    s_cbranch_vccnz L_E1_SB
    s_cmp_lg_u32 s63, 0
    s_cbranch_scc1 L_E1_NA
    buffer_store_dwordx4 v[72:75], v1, s[12:15], s75 offen offset:0
L_E1_NA:
    v_and_b32 v48, s9, v12
    v_lshlrev_b32 v40, 16, v12
    v_and_b32 v50, s9, v13
    v_lshlrev_b32 v42, 16, v13
    v_and_b32 v52, s9, v16
    v_lshlrev_b32 v44, 16, v16
    v_and_b32 v54, s9, v17
    v_lshlrev_b32 v46, 16, v17
    v_rcp_f32 v48, v48
    v_lshlrev_b32 v24, 16, v20
    v_and_b32 v25, s9, v20
    v_rcp_f32 v50, v50
    v_lshlrev_b32 v26, 16, v21
    v_and_b32 v27, s9, v21
    v_rcp_f32 v52, v52
    v_lshlrev_b32 v28, 16, v22
    v_and_b32 v29, s9, v22
    v_rcp_f32 v54, v54
    v_lshlrev_b32 v30, 16, v23
    v_and_b32 v31, s9, v23
    v_sub_f32 v32, v24, v40
    v_sub_f32 v33, v25, v40
    v_sub_f32 v34, v26, v42
    v_sub_f32 v35, v27, v42
    v_sub_f32 v36, v28, v44
    v_sub_f32 v37, v29, v44
    v_sub_f32 v38, v30, v46
    v_sub_f32 v39, v31, v46
    v_cvt_pk_bf16_f32 v33, v32, v33
    v_cvt_pk_bf16_f32 v35, v34, v35
    v_cvt_pk_bf16_f32 v37, v36, v37
    v_cvt_pk_bf16_f32 v39, v38, v39
    v_lshlrev_b32 v32, 16, v33
    v_and_b32 v33, s9, v33
    v_lshlrev_b32 v34, 16, v35
    v_and_b32 v35, s9, v35
    v_lshlrev_b32 v36, 16, v37
    v_and_b32 v37, s9, v37
    v_lshlrev_b32 v38, 16, v39
    v_and_b32 v39, s9, v39
    v_mul_f32 v32, v32, v48
    v_mul_f32 v33, v33, v48
    v_mul_f32 v34, v34, v50
    v_mul_f32 v35, v35, v50
    v_mul_f32 v36, v36, v52
    v_mul_f32 v37, v37, v52
    v_mul_f32 v38, v38, v54
    v_mul_f32 v39, v39, v54
    v_cvt_pk_bf16_f32 v8, v32, v34
    v_cvt_pk_bf16_f32 v9, v36, v38
    v_cvt_pk_bf16_f32 v10, v33, v35
    v_cvt_pk_bf16_f32 v11, v37, v39
    ds_write_b64 v3, v[8:9] offset:512
    ds_write_b64 v3, v[10:11] offset:5120
    ds_write_b32 v164, v165 offset:128
L_E1_WP:
    s_sub_u32 s3, s3, 1
    s_cbranch_scc1 L_END
    ds_read_b32 v4, v138
    ds_read_b128 v[140:143], v136
    ds_read_b128 v[144:147], v136 offset:4608
    s_waitcnt lgkmcnt(0)
    v_cmp_eq_u32 vcc, 0, v4
    s_cbranch_vccnz L_E1_WP
    v_mfma_f32_16x16x32_bf16 v[80:83], v[120:123], v[140:143], 0
    v_mfma_f32_16x16x32_bf16 v[96:99], v[120:123], v[144:147], 0
    v_mfma_f32_16x16x32_bf16 v[84:87], v[124:127], v[140:143], 0
    v_mfma_f32_16x16x32_bf16 v[100:103], v[124:127], v[144:147], 0
    s_cmp_ge_u32 s4, 4
    s_cbranch_scc1 L_E1_WH
    v_mfma_f32_16x16x32_bf16 v[88:91], v[128:131], v[140:143], 0
    v_mfma_f32_16x16x32_bf16 v[104:107], v[128:131], v[144:147], 0
    v_mfma_f32_16x16x32_bf16 v[92:95], v[132:135], v[140:143], 0
    v_mfma_f32_16x16x32_bf16 v[108:111], v[132:135], v[144:147], 0
    s_nop 4
    v_cvt_pk_bf16_f32 v88, v88, v89
    v_cvt_pk_bf16_f32 v89, v90, v91
    ds_write_b64 v137, v[88:89] offset:6912
    v_cvt_pk_bf16_f32 v104, v104, v105
    v_cvt_pk_bf16_f32 v105, v106, v107
    ds_write_b64 v137, v[104:105] offset:18400
    v_cvt_pk_bf16_f32 v92, v92, v93
    v_cvt_pk_bf16_f32 v93, v94, v95
    ds_write_b64 v137, v[92:93] offset:9264
    v_cvt_pk_bf16_f32 v108, v108, v109
    v_cvt_pk_bf16_f32 v109, v110, v111
    ds_write_b64 v137, v[108:109] offset:20752
L_E1_WH:
    s_nop 2
    v_cvt_pk_bf16_f32 v80, v80, v81
    v_cvt_pk_bf16_f32 v81, v82, v83
    ds_write_b64 v137, v[80:81] offset:0
    v_cvt_pk_bf16_f32 v96, v96, v97
    v_cvt_pk_bf16_f32 v97, v98, v99
    ds_write_b64 v137, v[96:97] offset:11488
    v_cvt_pk_bf16_f32 v84, v84, v85
    v_cvt_pk_bf16_f32 v85, v86, v87
    ds_write_b64 v137, v[84:85] offset:3456
    v_cvt_pk_bf16_f32 v100, v100, v101
    v_cvt_pk_bf16_f32 v101, v102, v103
    ds_write_b64 v137, v[100:101] offset:14944
    ds_write_b32 v164, v165 offset:240
    s_setprio 1
    s_lshl_b32 s65, s64, 6
    v_lshrrev_b32 v77, 0, v0
    v_add_u32 v77, s65, v77
    v_and_b32 v151, 0, v0
    s_lshl_b32 s67, s66, 13
    s_lshl_b32 s68, s4, 10
    s_add_u32 s67, s67, s68
    s_add_u32 s67, s67, 0x200000
    s_add_u32 s68, s67, 8192
    s_add_u32 s69, s67, 16384
    s_add_u32 s70, s67, 24576
    v_lshlrev_b32 v78, 2, v77
    v_lshl_add_u32 v78, v151, 15, v78
    s_lshl_b32 s71, s4, 18
    s_lshl_b32 s72, s66, 2
    s_add_u32 s71, s71, s72
    s_add_u32 s72, s71, 0x40000
    v_lshrrev_b32 v152, 2, v0
    v_and_b32 v153, 3, v0
    v_lshl_add_u32 v152, v153, 2, v152
    v_and_b32 v152, 15, v152
    v_lshl_add_u32 v152, v153, 4, v152
    s_lshl_b32 s26, s4, 11
    s_add_u32 s26, s26, 45504
    v_lshl_add_u32 v5, v152, 4, s26
    s_lshl_b32 s26, s4, 4
    s_add_u32 s26, s26, 144320
    v_lshl_add_u32 v6, v153, 2, s26
    s_mov_b32 s20, s56
    s_mov_b32 s21, s57
    s_mov_b32 s22, 0x200000
    s_mov_b32 s38, 0xbfb8aa3b
    s_lshl_b32 s36, s59, 16
    s_and_b32 s37, s59, s9
    v_lshlrev_b32 v32, 16, v8
    v_and_b32 v34, s9, v8
    v_lshlrev_b32 v36, 16, v9
    v_and_b32 v38, s9, v9
    v_lshlrev_b32 v33, 16, v10
    v_and_b32 v35, s9, v10
    v_lshlrev_b32 v37, 16, v11
    v_and_b32 v39, s9, v11
    v_mul_f32 v64, s38, v32
    v_mul_f32 v65, s38, v33
    v_mul_f32 v66, s38, v34
    v_mul_f32 v67, s38, v35
    v_mul_f32 v68, s38, v36
    v_mul_f32 v69, s38, v37
    v_mul_f32 v70, s38, v38
    v_mul_f32 v71, s38, v39
    v_exp_f32 v64, v64
    v_mul_f32 v40, s36, v32
    v_exp_f32 v65, v65
    v_mul_f32 v41, s37, v33
    v_exp_f32 v66, v66
    v_mul_f32 v42, s36, v34
    v_exp_f32 v67, v67
    v_mul_f32 v43, s37, v35
    v_exp_f32 v68, v68
    v_mul_f32 v44, s36, v36
    v_exp_f32 v69, v69
    v_mul_f32 v45, s37, v37
    v_exp_f32 v70, v70
    v_mul_f32 v46, s36, v38
    v_exp_f32 v71, v71
    v_mul_f32 v47, s37, v39
    v_add_f32 v64, 1.0, v64
    v_add_f32 v65, 1.0, v65
    v_add_f32 v66, 1.0, v66
    v_add_f32 v67, 1.0, v67
    v_add_f32 v68, 1.0, v68
    v_add_f32 v69, 1.0, v69
    v_add_f32 v70, 1.0, v70
    v_add_f32 v71, 1.0, v71
    v_rcp_f32 v56, v64
    v_rcp_f32 v57, v65
    v_rcp_f32 v58, v66
    v_rcp_f32 v59, v67
    v_rcp_f32 v60, v68
    v_rcp_f32 v61, v69
    v_rcp_f32 v62, v70
    v_rcp_f32 v63, v71
    s_cmp_lg_u32 s63, 0
    s_cbranch_scc1 L_E1_NB
    s_waitcnt vmcnt(0)
    s_mov_b64 exec, 1
    buffer_store_dword v166, off, s[12:15], s35 offset:0
    s_mov_b64 exec, -1
L_E1_NB:
    v_mul_f32 v56, v56, v32
    v_mul_f32 v57, v57, v33
    v_mul_f32 v58, v58, v34
    v_mul_f32 v59, v59, v35
    v_mul_f32 v60, v60, v36
    v_mul_f32 v61, v61, v37
    v_mul_f32 v62, v62, v38
    v_mul_f32 v63, v63, v39
    v_fmac_f32 v24, v40, v56
    v_fmac_f32 v25, v41, v57
    v_fmac_f32 v26, v42, v58
    v_fmac_f32 v27, v43, v59
    v_fmac_f32 v28, v44, v60
    v_fmac_f32 v29, v45, v61
    v_fmac_f32 v30, v46, v62
    v_fmac_f32 v31, v47, v63
    v_mov_b32 v14, 144528
    v_bfrev_b32 v12, 1
    v_lshlrev_b32 v13, 10, v77
    v_lshl_add_u32 v13, v151, 4, v13
L_E1_SPT:
    s_sub_u32 s3, s3, 1
    s_cbranch_scc1 L_END
    ds_read_b64 v[16:17], v14
    s_waitcnt lgkmcnt(0)
    v_readfirstlane_b32 s62, v16
    v_readfirstlane_b32 s29, v17
    v_cmp_eq_u32 vcc, 0, v16
    s_cbranch_vccnz L_E1_SPT
    s_and_b32 s28, s62, 0x7ff
    s_and_b32 s29, s29, 0x7ff
    s_lshl_b32 s26, s4, 8
    s_sub_u32 s26, 2047, s26
    s_sub_u32 s28, s26, s28
    s_sub_u32 s29, s26, s29
    v_cmp_eq_u32 vcc, s28, v77
    v_cmp_eq_u32 s[24:25], s29, v77
    s_or_b64 vcc, vcc, s[24:25]
    v_cndmask_b32 v79, v13, v12, vcc
    s_bitcmp0_b32 s62, 14
    s_cbranch_scc1 L_E1_G
    s_cmp_lg_u32 s63, 0
    s_cbranch_scc1 L_E1_XW
L_E1_XWD:
    buffer_load_dword v4, v7, s[12:15], s34 offen sc1
L_E1_D0:
    s_sub_u32 s3, s3, 1
    s_cbranch_scc1 L_END
    ds_read_b32 v72, v6 offset:0
    s_waitcnt lgkmcnt(0)
    v_cmp_eq_u32 vcc, 0, v72
    s_cbranch_vccnz L_E1_D0
    s_setprio 3
    ds_read_b128 v[8:11], v5 offset:0
    ds_read_b128 v[12:15], v5 offset:1024
    ds_read_b128 v[16:19], v5 offset:33792
    ds_read_b128 v[20:23], v5 offset:34816
    s_waitcnt lgkmcnt(2)
    v_add_f32 v64, v8, v12
    v_add_f32 v66, v9, v13
    v_add_f32 v68, v10, v14
    v_add_f32 v70, v11, v15
    v_fmac_f32 v24, v64, v56
    v_fmac_f32 v26, v66, v58
    v_fmac_f32 v28, v68, v60
    v_fmac_f32 v30, v70, v62
    s_waitcnt lgkmcnt(0)
    v_add_f32 v65, v16, v20
    v_add_f32 v67, v17, v21
    v_add_f32 v69, v18, v22
    v_add_f32 v71, v19, v23
    v_fmac_f32 v25, v65, v57
    v_fmac_f32 v27, v67, v59
    v_fmac_f32 v29, v69, v61
    v_fmac_f32 v31, v71, v63
    v_cvt_pk_bf16_f32 v72, v24, v25
    v_cvt_pk_bf16_f32 v73, v26, v27
    v_cvt_pk_bf16_f32 v74, v28, v29
    v_cvt_pk_bf16_f32 v75, v30, v31
    v_min_u32 v72, -2, v72
    v_min_u32 v73, -2, v73
    v_min_u32 v74, -2, v74
    v_min_u32 v75, -2, v75
    buffer_store_dwordx4 v[72:75], v1, s[12:15], s75 offen offset:0
    s_setprio 1
    s_waitcnt vmcnt(1)
    v_cmp_ne_u32 vcc, s8, v4
    s_cbranch_vccnz L_E1_OA
L_E1_OP:
    s_sub_u32 s3, s3, 4
    s_cbranch_scc1 L_END
    buffer_load_dword v8, v78, s[12:15], s67 offen offset:0 sc1
    buffer_load_dword v9, v78, s[12:15], s68 offen offset:0 sc1
    buffer_load_dword v10, v78, s[12:15], s69 offen offset:0 sc1
    buffer_load_dword v11, v78, s[12:15], s70 offen offset:0 sc1
    s_waitcnt vmcnt(0)
    v_max3_u32 v16, v8, v9, v10
    v_max_u32 v16, v16, v11
    v_cmp_eq_u32 vcc, -1, v16
    s_cbranch_vccnz L_E1_OPB
    buffer_store_dwordx4 v[8:11], v79, s[20:23], s71 offen
    s_endpgm
L_E1_OPB:
    s_branch L_E1_OP
L_E2_X:
    v_and_b32 v2, 31, v0
    v_lshlrev_b32 v2, 2, v2
    v_and_b32 v7, 7, v0
    v_lshlrev_b32 v7, 2, v7
    v_and_b32 v8, 15, v0
    v_lshrrev_b32 v9, 4, v0
    v_lshlrev_b32 v10, 3, v9
    v_sub_u32 v10, v8, v10
    v_add_u32 v10, 12, v10
    v_and_b32 v10, 0xffff, v10
    v_lshl_or_b32 v10, v10, 16, v10
    s_mov_b32 s40, 0x3f803f80
    s_mov_b32 s41, 0x10000
    v_pk_sub_i16 v11, v10, s41
    v_pk_sub_i16 v12, s41, v10
    v_pk_max_i16 v11, v11, v12
    v_pk_sub_i16 v12, v11, 3 op_sel_hi:[1,0]
    v_pk_ashrrev_i16 v12, 15, v12 op_sel_hi:[0,1]
    v_and_b32 v120, s40, v12
    v_pk_sub_i16 v12, v11, 2 op_sel_hi:[1,0]
    v_pk_ashrrev_i16 v12, 15, v12 op_sel_hi:[0,1]
    v_and_b32 v124, s40, v12
    v_pk_sub_i16 v12, v11, 5 op_sel_hi:[1,0]
    v_pk_ashrrev_i16 v12, 15, v12 op_sel_hi:[0,1]
    v_and_b32 v128, s40, v12
    v_pk_sub_i16 v12, v11, 4 op_sel_hi:[1,0]
    v_pk_ashrrev_i16 v12, 15, v12 op_sel_hi:[0,1]
    v_and_b32 v132, s40, v12
    s_mov_b32 s41, 0x30002
    v_pk_sub_i16 v11, v10, s41
    v_pk_sub_i16 v12, s41, v10
    v_pk_max_i16 v11, v11, v12
    v_pk_sub_i16 v12, v11, 3 op_sel_hi:[1,0]
    v_pk_ashrrev_i16 v12, 15, v12 op_sel_hi:[0,1]
    v_and_b32 v121, s40, v12
    v_pk_sub_i16 v12, v11, 2 op_sel_hi:[1,0]
    v_pk_ashrrev_i16 v12, 15, v12 op_sel_hi:[0,1]
    v_and_b32 v125, s40, v12
    v_pk_sub_i16 v12, v11, 5 op_sel_hi:[1,0]
    v_pk_ashrrev_i16 v12, 15, v12 op_sel_hi:[0,1]
    v_and_b32 v129, s40, v12
    v_pk_sub_i16 v12, v11, 4 op_sel_hi:[1,0]
    v_pk_ashrrev_i16 v12, 15, v12 op_sel_hi:[0,1]
    v_and_b32 v133, s40, v12
    s_mov_b32 s41, 0x50004
    v_pk_sub_i16 v11, v10, s41
    v_pk_sub_i16 v12, s41, v10
    v_pk_max_i16 v11, v11, v12
    v_pk_sub_i16 v12, v11, 3 op_sel_hi:[1,0]
    v_pk_ashrrev_i16 v12, 15, v12 op_sel_hi:[0,1]
    v_and_b32 v122, s40, v12
    v_pk_sub_i16 v12, v11, 2 op_sel_hi:[1,0]
    v_pk_ashrrev_i16 v12, 15, v12 op_sel_hi:[0,1]
    v_and_b32 v126, s40, v12
    v_pk_sub_i16 v12, v11, 5 op_sel_hi:[1,0]
    v_pk_ashrrev_i16 v12, 15, v12 op_sel_hi:[0,1]
    v_and_b32 v130, s40, v12
    v_pk_sub_i16 v12, v11, 4 op_sel_hi:[1,0]
    v_pk_ashrrev_i16 v12, 15, v12 op_sel_hi:[0,1]
    v_and_b32 v134, s40, v12
    s_mov_b32 s41, 0x70006
    v_pk_sub_i16 v11, v10, s41
    v_pk_sub_i16 v12, s41, v10
    v_pk_max_i16 v11, v11, v12
    v_pk_sub_i16 v12, v11, 3 op_sel_hi:[1,0]
    v_pk_ashrrev_i16 v12, 15, v12 op_sel_hi:[0,1]
    v_and_b32 v123, s40, v12
    v_pk_sub_i16 v12, v11, 2 op_sel_hi:[1,0]
    v_pk_ashrrev_i16 v12, 15, v12 op_sel_hi:[0,1]
    v_and_b32 v127, s40, v12
    v_pk_sub_i16 v12, v11, 5 op_sel_hi:[1,0]
    v_pk_ashrrev_i16 v12, 15, v12 op_sel_hi:[0,1]
    v_and_b32 v131, s40, v12
    v_pk_sub_i16 v12, v11, 4 op_sel_hi:[1,0]
    v_pk_ashrrev_i16 v12, 15, v12 op_sel_hi:[0,1]
    v_and_b32 v135, s40, v12
    ds_write_b128 v139, v[120:123] offset:0
    ds_write_b128 v139, v[124:127] offset:1024
    ds_write_b128 v139, v[128:131] offset:2048
    ds_write_b128 v139, v[132:135] offset:3072
    ds_write_b32 v164, v165 offset:240
L_E2_XP:
    s_sub_u32 s28, s28, 1
    s_cbranch_scc1 L_E2_XG
    buffer_load_dword v4, v2, s[12:15], s10 offen sc1
    s_waitcnt vmcnt(0)
    v_cmp_ne_u32 vcc, s74, v4
    s_cbranch_vccnz L_E2_XP
    buffer_load_dwordx4 v[20:23], v1, s[12:15], s75 offen offset:0 sc1
    buffer_load_dwordx4 v[112:115], v1, s[12:15], s75 offen offset:1024 sc1
L_E2_X2:
    buffer_load_dwordx4 v[12:15], v1, s[12:15], s11 offen offset:0 sc1
    buffer_load_dwordx4 v[16:19], v1, s[12:15], s11 offen offset:1024 sc1
    buffer_load_dwordx4 v[104:107], v1, s[12:15], s11 offen offset:2048 sc1
    buffer_load_dwordx4 v[108:111], v1, s[12:15], s11 offen offset:3072 sc1
    s_lshl_b32 s24, s4, 9
    v_lshl_add_u32 v3, v0, 3, s24
    s_and_b32 s66, s7, 252
    s_lshl_b32 s34, s66, 5
    s_lshl_b32 s35, s4, 4
    s_add_u32 s34, s34, s35
    s_add_u32 s34, s34, 0xa000
    s_and_b32 s64, s6, 3
    s_lshl_b32 s35, s64, 2
    s_add_u32 s35, s35, s34
    v_mov_b32 v72, -1
    v_mov_b32 v73, -1
    v_mov_b32 v74, -1
    v_mov_b32 v75, -1
    v_mov_b32 v166, s8
    s_setprio 1
L_E2_S2:
    s_waitcnt vmcnt(0)
    v_xor_b32 v15, s8, v15
    v_xor_b32 v19, s8, v19
    v_xor_b32 v107, s8, v107
    v_xor_b32 v111, s8, v111
    v_or_b32 v15, v15, v19
    v_or3_b32 v15, v15, v107, v111
    v_cmp_ne_u32 vcc, 0, v15
    s_cbranch_vccnz L_E2_SB
    s_cmp_lg_u32 s63, 0
    s_cbranch_scc1 L_E2_NA
    buffer_store_dwordx4 v[72:75], v1, s[12:15], s75 offen offset:0
    buffer_store_dwordx4 v[72:75], v1, s[12:15], s75 offen offset:1024
L_E2_NA:
    v_and_b32 v48, s9, v12
    v_lshlrev_b32 v40, 16, v12
    v_and_b32 v50, s9, v13
    v_lshlrev_b32 v42, 16, v13
    v_and_b32 v52, s9, v16
    v_lshlrev_b32 v44, 16, v16
    v_and_b32 v54, s9, v17
    v_lshlrev_b32 v46, 16, v17
    v_rcp_f32 v48, v48
    v_lshlrev_b32 v24, 16, v20
    v_and_b32 v25, s9, v20
    v_rcp_f32 v50, v50
    v_lshlrev_b32 v26, 16, v21
    v_and_b32 v27, s9, v21
    v_rcp_f32 v52, v52
    v_lshlrev_b32 v28, 16, v22
    v_and_b32 v29, s9, v22
    v_rcp_f32 v54, v54
    v_lshlrev_b32 v30, 16, v23
    v_and_b32 v31, s9, v23
    v_sub_f32 v32, v24, v40
    v_sub_f32 v33, v25, v40
    v_sub_f32 v34, v26, v42
    v_sub_f32 v35, v27, v42
    v_sub_f32 v36, v28, v44
    v_sub_f32 v37, v29, v44
    v_sub_f32 v38, v30, v46
    v_sub_f32 v39, v31, v46
    v_cvt_pk_bf16_f32 v33, v32, v33
    v_cvt_pk_bf16_f32 v35, v34, v35
    v_cvt_pk_bf16_f32 v37, v36, v37
    v_cvt_pk_bf16_f32 v39, v38, v39
    v_lshlrev_b32 v32, 16, v33
    v_and_b32 v33, s9, v33
    v_lshlrev_b32 v34, 16, v35
    v_and_b32 v35, s9, v35
    v_lshlrev_b32 v36, 16, v37
    v_and_b32 v37, s9, v37
    v_lshlrev_b32 v38, 16, v39
    v_and_b32 v39, s9, v39
    v_mul_f32 v32, v32, v48
    v_mul_f32 v33, v33, v48
    v_mul_f32 v34, v34, v50
    v_mul_f32 v35, v35, v50
    v_mul_f32 v36, v36, v52
    v_mul_f32 v37, v37, v52
    v_mul_f32 v38, v38, v54
    v_mul_f32 v39, v39, v54
    v_cvt_pk_bf16_f32 v8, v32, v34
    v_cvt_pk_bf16_f32 v9, v36, v38
    v_cvt_pk_bf16_f32 v10, v33, v35
    v_cvt_pk_bf16_f32 v11, v37, v39
    ds_write_b64 v3, v[8:9] offset:512
    ds_write_b64 v3, v[10:11] offset:5120
    ds_write_b32 v164, v165 offset:128
    v_and_b32 v48, s9, v104
    v_lshlrev_b32 v40, 16, v104
    v_and_b32 v50, s9, v105
    v_lshlrev_b32 v42, 16, v105
    v_and_b32 v52, s9, v108
    v_lshlrev_b32 v44, 16, v108
    v_and_b32 v54, s9, v109
    v_lshlrev_b32 v46, 16, v109
    v_rcp_f32 v48, v48
    v_lshlrev_b32 v80, 16, v112
    v_and_b32 v81, s9, v112
    v_rcp_f32 v50, v50
    v_lshlrev_b32 v82, 16, v113
    v_and_b32 v83, s9, v113
    v_rcp_f32 v52, v52
    v_lshlrev_b32 v84, 16, v114
    v_and_b32 v85, s9, v114
    v_rcp_f32 v54, v54
    v_lshlrev_b32 v86, 16, v115
    v_and_b32 v87, s9, v115
    v_sub_f32 v32, v80, v40
    v_sub_f32 v33, v81, v40
    v_sub_f32 v34, v82, v42
    v_sub_f32 v35, v83, v42
    v_sub_f32 v36, v84, v44
    v_sub_f32 v37, v85, v44
    v_sub_f32 v38, v86, v46
    v_sub_f32 v39, v87, v46
    v_cvt_pk_bf16_f32 v33, v32, v33
    v_cvt_pk_bf16_f32 v35, v34, v35
    v_cvt_pk_bf16_f32 v37, v36, v37
    v_cvt_pk_bf16_f32 v39, v38, v39
    v_lshlrev_b32 v32, 16, v33
    v_and_b32 v33, s9, v33
    v_lshlrev_b32 v34, 16, v35
    v_and_b32 v35, s9, v35
    v_lshlrev_b32 v36, 16, v37
    v_and_b32 v37, s9, v37
    v_lshlrev_b32 v38, 16, v39
    v_and_b32 v39, s9, v39
    v_mul_f32 v32, v32, v48
    v_mul_f32 v33, v33, v48
    v_mul_f32 v34, v34, v50
    v_mul_f32 v35, v35, v50
    v_mul_f32 v36, v36, v52
    v_mul_f32 v37, v37, v52
    v_mul_f32 v38, v38, v54
    v_mul_f32 v39, v39, v54
    v_cvt_pk_bf16_f32 v96, v32, v34
    v_cvt_pk_bf16_f32 v97, v36, v38
    v_cvt_pk_bf16_f32 v98, v33, v35
    v_cvt_pk_bf16_f32 v99, v37, v39
    ds_write_b64 v3, v[96:97] offset:1024
    ds_write_b64 v3, v[98:99] offset:5632
    ds_write_b32 v164, v165 offset:132
    s_setprio 1
    s_lshl_b32 s65, s64, 6
    v_lshrrev_b32 v77, 0, v0
    v_add_u32 v77, s65, v77
    v_and_b32 v151, 0, v0
    s_lshl_b32 s67, s66, 13
    s_lshl_b32 s68, s4, 10
    s_add_u32 s67, s67, s68
    s_add_u32 s67, s67, 0x200000
    s_add_u32 s68, s67, 8192
    s_add_u32 s69, s67, 16384
    s_add_u32 s70, s67, 24576
    v_lshlrev_b32 v78, 2, v77
    v_lshl_add_u32 v78, v151, 15, v78
    s_lshl_b32 s71, s4, 18
    s_lshl_b32 s72, s66, 2
    s_add_u32 s71, s71, s72
    s_add_u32 s72, s71, 0x40000
    v_lshrrev_b32 v152, 2, v0
    v_and_b32 v153, 3, v0
    v_lshl_add_u32 v152, v153, 2, v152
    v_and_b32 v152, 15, v152
    v_lshl_add_u32 v152, v153, 4, v152
    s_lshl_b32 s26, s4, 11
    s_add_u32 s26, s26, 45504
    v_lshl_add_u32 v5, v152, 4, s26
    s_lshl_b32 s26, s4, 4
    s_add_u32 s26, s26, 144320
    v_lshl_add_u32 v6, v153, 2, s26
    s_mov_b32 s20, s56
    s_mov_b32 s21, s57
    s_mov_b32 s22, 0x200000
    s_mov_b32 s38, 0xbfb8aa3b
    s_lshl_b32 s36, s59, 16
    s_and_b32 s37, s59, s9
    v_lshlrev_b32 v32, 16, v8
    v_and_b32 v34, s9, v8
    v_lshlrev_b32 v36, 16, v9
    v_and_b32 v38, s9, v9
    v_lshlrev_b32 v33, 16, v10
    v_and_b32 v35, s9, v10
    v_lshlrev_b32 v37, 16, v11
    v_and_b32 v39, s9, v11
    v_mul_f32 v64, s38, v32
    v_mul_f32 v65, s38, v33
    v_mul_f32 v66, s38, v34
    v_mul_f32 v67, s38, v35
    v_mul_f32 v68, s38, v36
    v_mul_f32 v69, s38, v37
    v_mul_f32 v70, s38, v38
    v_mul_f32 v71, s38, v39
    v_exp_f32 v64, v64
    v_mul_f32 v40, s36, v32
    v_exp_f32 v65, v65
    v_mul_f32 v41, s37, v33
    v_exp_f32 v66, v66
    v_mul_f32 v42, s36, v34
    v_exp_f32 v67, v67
    v_mul_f32 v43, s37, v35
    v_exp_f32 v68, v68
    v_mul_f32 v44, s36, v36
    v_exp_f32 v69, v69
    v_mul_f32 v45, s37, v37
    v_exp_f32 v70, v70
    v_mul_f32 v46, s36, v38
    v_exp_f32 v71, v71
    v_mul_f32 v47, s37, v39
    v_add_f32 v64, 1.0, v64
    v_add_f32 v65, 1.0, v65
    v_add_f32 v66, 1.0, v66
    v_add_f32 v67, 1.0, v67
    v_add_f32 v68, 1.0, v68
    v_add_f32 v69, 1.0, v69
    v_add_f32 v70, 1.0, v70
    v_add_f32 v71, 1.0, v71
    v_rcp_f32 v56, v64
    v_rcp_f32 v57, v65
    v_rcp_f32 v58, v66
    v_rcp_f32 v59, v67
    v_rcp_f32 v60, v68
    v_rcp_f32 v61, v69
    v_rcp_f32 v62, v70
    v_rcp_f32 v63, v71
    s_cmp_lg_u32 s63, 0
    s_cbranch_scc1 L_E2_NB
    s_waitcnt vmcnt(0)
    s_mov_b64 exec, 1
    buffer_store_dword v166, off, s[12:15], s35 offset:0
    buffer_store_dword v166, off, s[12:15], s35 offset:16
    s_mov_b64 exec, -1
L_E2_NB:
    v_mul_f32 v56, v56, v32
    v_mul_f32 v57, v57, v33
    v_mul_f32 v58, v58, v34
    v_mul_f32 v59, v59, v35
    v_mul_f32 v60, v60, v36
    v_mul_f32 v61, v61, v37
    v_mul_f32 v62, v62, v38
    v_mul_f32 v63, v63, v39
    v_fmac_f32 v24, v40, v56
    v_fmac_f32 v25, v41, v57
    v_fmac_f32 v26, v42, v58
    v_fmac_f32 v27, v43, v59
    v_fmac_f32 v28, v44, v60
    v_fmac_f32 v29, v45, v61
    v_fmac_f32 v30, v46, v62
    v_fmac_f32 v31, v47, v63
    v_lshlrev_b32 v32, 16, v96
    v_and_b32 v34, s9, v96
    v_lshlrev_b32 v36, 16, v97
    v_and_b32 v38, s9, v97
    v_lshlrev_b32 v33, 16, v98
    v_and_b32 v35, s9, v98
    v_lshlrev_b32 v37, 16, v99
    v_and_b32 v39, s9, v99
    v_mul_f32 v64, s38, v32
    v_mul_f32 v65, s38, v33
    v_mul_f32 v66, s38, v34
    v_mul_f32 v67, s38, v35
    v_mul_f32 v68, s38, v36
    v_mul_f32 v69, s38, v37
    v_mul_f32 v70, s38, v38
    v_mul_f32 v71, s38, v39
    v_exp_f32 v64, v64
    v_mul_f32 v40, s36, v32
    v_exp_f32 v65, v65
    v_mul_f32 v41, s37, v33
    v_exp_f32 v66, v66
    v_mul_f32 v42, s36, v34
    v_exp_f32 v67, v67
    v_mul_f32 v43, s37, v35
    v_exp_f32 v68, v68
    v_mul_f32 v44, s36, v36
    v_exp_f32 v69, v69
    v_mul_f32 v45, s37, v37
    v_exp_f32 v70, v70
    v_mul_f32 v46, s36, v38
    v_exp_f32 v71, v71
    v_mul_f32 v47, s37, v39
    v_add_f32 v64, 1.0, v64
    v_add_f32 v65, 1.0, v65
    v_add_f32 v66, 1.0, v66
    v_add_f32 v67, 1.0, v67
    v_add_f32 v68, 1.0, v68
    v_add_f32 v69, 1.0, v69
    v_add_f32 v70, 1.0, v70
    v_add_f32 v71, 1.0, v71
    v_rcp_f32 v88, v64
    v_rcp_f32 v89, v65
    v_rcp_f32 v90, v66
    v_rcp_f32 v91, v67
    v_rcp_f32 v92, v68
    v_rcp_f32 v93, v69
    v_rcp_f32 v94, v70
    v_rcp_f32 v95, v71
    s_nop 0
    v_mul_f32 v88, v88, v32
    v_mul_f32 v89, v89, v33
    v_mul_f32 v90, v90, v34
    v_mul_f32 v91, v91, v35
    v_mul_f32 v92, v92, v36
    v_mul_f32 v93, v93, v37
    v_mul_f32 v94, v94, v38
    v_mul_f32 v95, v95, v39
    v_fmac_f32 v80, v40, v88
    v_fmac_f32 v81, v41, v89
    v_fmac_f32 v82, v42, v90
    v_fmac_f32 v83, v43, v91
    v_fmac_f32 v84, v44, v92
    v_fmac_f32 v85, v45, v93
    v_fmac_f32 v86, v46, v94
    v_fmac_f32 v87, v47, v95
    v_mov_b32 v14, 144528
    v_bfrev_b32 v12, 1
    v_lshlrev_b32 v13, 10, v77
    v_lshl_add_u32 v13, v151, 4, v13
L_E2_SPT:
    s_sub_u32 s3, s3, 1
    s_cbranch_scc1 L_END
    ds_read_b64 v[16:17], v14
    s_waitcnt lgkmcnt(0)
    v_readfirstlane_b32 s62, v16
    v_readfirstlane_b32 s29, v17
    v_cmp_eq_u32 vcc, 0, v16
    s_cbranch_vccnz L_E2_SPT
    s_and_b32 s28, s62, 0x7ff
    s_and_b32 s29, s29, 0x7ff
    s_lshl_b32 s26, s4, 8
    s_sub_u32 s26, 2047, s26
    s_sub_u32 s28, s26, s28
    s_sub_u32 s29, s26, s29
    v_cmp_eq_u32 vcc, s28, v77
    v_cmp_eq_u32 s[24:25], s29, v77
    s_or_b64 vcc, vcc, s[24:25]
    v_cndmask_b32 v79, v13, v12, vcc
    v_add_u32 v77, 256, v77
    v_cmp_eq_u32 vcc, s28, v77
    v_cmp_eq_u32 s[24:25], s29, v77
    s_or_b64 vcc, vcc, s[24:25]
    v_cndmask_b32 v116, v13, v12, vcc
    s_bitcmp0_b32 s62, 14
    s_cbranch_scc1 L_E2_G
    s_cmp_lg_u32 s63, 0
    s_cbranch_scc1 L_E2_XW
L_E2_XWD:
    buffer_load_dword v4, v7, s[12:15], s34 offen sc1
L_E2_D0:
    s_sub_u32 s3, s3, 1
    s_cbranch_scc1 L_END
    ds_read_b32 v72, v6 offset:0
    s_waitcnt lgkmcnt(0)
    v_cmp_eq_u32 vcc, 0, v72
    s_cbranch_vccnz L_E2_D0
    s_setprio 3
    ds_read_b128 v[8:11], v5 offset:0
    ds_read_b128 v[12:15], v5 offset:1024
    ds_read_b128 v[16:19], v5 offset:33792
    ds_read_b128 v[20:23], v5 offset:34816
    s_waitcnt lgkmcnt(2)
    v_add_f32 v64, v8, v12
    v_add_f32 v66, v9, v13
    v_add_f32 v68, v10, v14
    v_add_f32 v70, v11, v15
    v_fmac_f32 v24, v64, v56
    v_fmac_f32 v26, v66, v58
    v_fmac_f32 v28, v68, v60
    v_fmac_f32 v30, v70, v62
    s_waitcnt lgkmcnt(0)
    v_add_f32 v65, v16, v20
    v_add_f32 v67, v17, v21
    v_add_f32 v69, v18, v22
    v_add_f32 v71, v19, v23
    v_fmac_f32 v25, v65, v57
    v_fmac_f32 v27, v67, v59
    v_fmac_f32 v29, v69, v61
    v_fmac_f32 v31, v71, v63
    v_cvt_pk_bf16_f32 v72, v24, v25
    v_cvt_pk_bf16_f32 v73, v26, v27
    v_cvt_pk_bf16_f32 v74, v28, v29
    v_cvt_pk_bf16_f32 v75, v30, v31
    v_min_u32 v72, -2, v72
    v_min_u32 v73, -2, v73
    v_min_u32 v74, -2, v74
    v_min_u32 v75, -2, v75
    buffer_store_dwordx4 v[72:75], v1, s[12:15], s75 offen offset:0
L_E2_D1:
    s_sub_u32 s3, s3, 1
    s_cbranch_scc1 L_END
    ds_read_b32 v100, v6 offset:16
    s_waitcnt lgkmcnt(0)
    v_cmp_eq_u32 vcc, 0, v100
    s_cbranch_vccnz L_E2_D1
    s_setprio 3
    ds_read_b128 v[8:11], v5 offset:2048
    ds_read_b128 v[12:15], v5 offset:3072
    ds_read_b128 v[16:19], v5 offset:35840
    ds_read_b128 v[20:23], v5 offset:36864
    s_waitcnt lgkmcnt(2)
    v_add_f32 v64, v8, v12
    v_add_f32 v66, v9, v13
    v_add_f32 v68, v10, v14
    v_add_f32 v70, v11, v15
    v_fmac_f32 v80, v64, v88
    v_fmac_f32 v82, v66, v90
    v_fmac_f32 v84, v68, v92
    v_fmac_f32 v86, v70, v94
    s_waitcnt lgkmcnt(0)
    v_add_f32 v65, v16, v20
    v_add_f32 v67, v17, v21
    v_add_f32 v69, v18, v22
    v_add_f32 v71, v19, v23
    v_fmac_f32 v81, v65, v89
    v_fmac_f32 v83, v67, v91
    v_fmac_f32 v85, v69, v93
    v_fmac_f32 v87, v71, v95
    v_cvt_pk_bf16_f32 v100, v80, v81
    v_cvt_pk_bf16_f32 v101, v82, v83
    v_cvt_pk_bf16_f32 v102, v84, v85
    v_cvt_pk_bf16_f32 v103, v86, v87
    v_min_u32 v100, -2, v100
    v_min_u32 v101, -2, v101
    v_min_u32 v102, -2, v102
    v_min_u32 v103, -2, v103
    buffer_store_dwordx4 v[100:103], v1, s[12:15], s75 offen offset:1024
    s_setprio 1
    s_waitcnt vmcnt(2)
    v_cmp_ne_u32 vcc, s8, v4
    s_cbranch_vccnz L_E2_OA
L_E2_OP:
    s_sub_u32 s3, s3, 4
    s_cbranch_scc1 L_END
    buffer_load_dword v8, v78, s[12:15], s67 offen offset:0 sc1
    buffer_load_dword v9, v78, s[12:15], s68 offen offset:0 sc1
    buffer_load_dword v10, v78, s[12:15], s69 offen offset:0 sc1
    buffer_load_dword v11, v78, s[12:15], s70 offen offset:0 sc1
    buffer_load_dword v12, v78, s[12:15], s67 offen offset:1024 sc1
    buffer_load_dword v13, v78, s[12:15], s68 offen offset:1024 sc1
    buffer_load_dword v14, v78, s[12:15], s69 offen offset:1024 sc1
    buffer_load_dword v15, v78, s[12:15], s70 offen offset:1024 sc1
    s_waitcnt vmcnt(0)
    v_max3_u32 v16, v8, v9, v10
    v_max3_u32 v17, v12, v13, v14
    v_max3_u32 v16, v16, v17, v15
    v_max_u32 v16, v16, v11
    v_cmp_eq_u32 vcc, -1, v16
    s_cbranch_vccnz L_E2_OPB
    buffer_store_dwordx4 v[8:11], v79, s[20:23], s71 offen
    buffer_store_dwordx4 v[12:15], v116, s[20:23], s72 offen
    s_endpgm
L_E2_OPB:
    s_branch L_E2_OP
L_K_POLL_B:
    s_sleep 1
    s_branch L_K_POLL
L_F_PA_B:
    s_sleep 1
    s_branch L_F_PA
L_EL_TAGW:
    s_sub_u32 s3, s3, 1
    s_cbranch_scc1 L_END
    ds_read_b32 v35, v37 offset:12
    s_waitcnt lgkmcnt(0)
    v_cmp_eq_u32 vcc, 0, v35
    s_cbranch_vccnz L_EL_TAGW
    s_branch L_EL_TAGOK
L_EL_SLOWVAR:
    v_mov_b32 v26, 0
    v_lshlrev_b32 v27, 16, v8
    v_sub_f32 v27, v27, v24
    v_fmac_f32 v26, v27, v27
    v_and_b32 v27, s9, v8
    v_sub_f32 v27, v27, v24
    v_fmac_f32 v26, v27, v27
    v_lshlrev_b32 v27, 16, v9
    v_sub_f32 v27, v27, v24
    v_fmac_f32 v26, v27, v27
    v_and_b32 v27, s9, v9
    v_sub_f32 v27, v27, v24
    v_fmac_f32 v26, v27, v27
    v_lshlrev_b32 v27, 16, v10
    v_sub_f32 v27, v27, v24
    v_fmac_f32 v26, v27, v27
    v_and_b32 v27, s9, v10
    v_sub_f32 v27, v27, v24
    v_fmac_f32 v26, v27, v27
    v_lshlrev_b32 v27, 16, v11
    v_sub_f32 v27, v27, v24
    v_fmac_f32 v26, v27, v27
    v_and_b32 v27, s9, v11
    v_sub_f32 v27, v27, v24
    v_fmac_f32 v26, v27, v27
    v_lshlrev_b32 v27, 16, v12
    v_sub_f32 v27, v27, v24
    v_fmac_f32 v26, v27, v27
    v_and_b32 v27, s9, v12
    v_sub_f32 v27, v27, v24
    v_fmac_f32 v26, v27, v27
    v_lshlrev_b32 v27, 16, v13
    v_sub_f32 v27, v27, v24
    v_fmac_f32 v26, v27, v27
    v_and_b32 v27, s9, v13
    v_sub_f32 v27, v27, v24
    v_fmac_f32 v26, v27, v27
    v_lshlrev_b32 v27, 16, v14
    v_sub_f32 v27, v27, v24
    v_fmac_f32 v26, v27, v27
    v_and_b32 v27, s9, v14
    v_sub_f32 v27, v27, v24
    v_fmac_f32 v26, v27, v27
    v_lshlrev_b32 v27, 16, v15
    v_sub_f32 v27, v27, v24
    v_fmac_f32 v26, v27, v27
    v_and_b32 v27, s9, v15
    v_sub_f32 v27, v27, v24
    v_fmac_f32 v26, v27, v27
    s_nop 1
    v_add_f32_dpp v26, v26, v26 row_ror:8 row_mask:0xf bank_mask:0xf
    s_nop 1
    v_add_f32_dpp v26, v26, v26 row_ror:4 row_mask:0xf bank_mask:0xf
    s_nop 1
    v_add_f32_dpp v26, v26, v26 row_ror:2 row_mask:0xf bank_mask:0xf
    s_nop 1
    v_add_f32_dpp v26, v26, v26 row_ror:1 row_mask:0xf bank_mask:0xf
    v_mov_b32 v27, v26
    s_nop 1
    v_permlane16_swap_b32 v26, v27
    s_nop 0
    v_add_f32 v26, v26, v27
    v_mul_f32 v26, v26, v28
    s_branch L_EL_VAROK
L_E1_XG:
    s_mov_b32 s63, 1
    buffer_load_dword v20, v76, s[16:19], s30 offen offset:0
    buffer_load_dword v21, v76, s[16:19], s30 offen offset:1024
    buffer_load_dword v22, v76, s[16:19], s30 offen offset:2048
    buffer_load_dword v23, v76, s[16:19], s30 offen offset:3072
    s_branch L_E1_X2
L_E1_SB:
    s_sub_u32 s3, s3, 20
    s_cbranch_scc1 L_END
    s_sleep 1
    buffer_load_dwordx4 v[12:15], v1, s[12:15], s11 offen offset:0 sc1
    buffer_load_dwordx4 v[16:19], v1, s[12:15], s11 offen offset:1024 sc1
    s_branch L_E1_S2
L_E2_XG:
    s_mov_b32 s63, 1
    buffer_load_dword v20, v76, s[16:19], s30 offen offset:0
    buffer_load_dword v21, v76, s[16:19], s30 offen offset:1024
    buffer_load_dword v22, v76, s[16:19], s30 offen offset:2048
    buffer_load_dword v23, v76, s[16:19], s30 offen offset:3072
    buffer_load_dword v112, v76, s[16:19], s33 offen offset:0
    buffer_load_dword v113, v76, s[16:19], s33 offen offset:1024
    buffer_load_dword v114, v76, s[16:19], s33 offen offset:2048
    buffer_load_dword v115, v76, s[16:19], s33 offen offset:3072
    s_branch L_E2_X2
L_E2_SB:
    s_sub_u32 s3, s3, 20
    s_cbranch_scc1 L_END
    s_sleep 1
    buffer_load_dwordx4 v[12:15], v1, s[12:15], s11 offen offset:0 sc1
    buffer_load_dwordx4 v[16:19], v1, s[12:15], s11 offen offset:1024 sc1
    buffer_load_dwordx4 v[104:107], v1, s[12:15], s11 offen offset:2048 sc1
    buffer_load_dwordx4 v[108:111], v1, s[12:15], s11 offen offset:3072 sc1
    s_branch L_E2_S2
L_EF:
    v_and_b32 v100, 3, v0
    v_lshlrev_b32 v101, 9, v100
    v_and_b32 v102, 60, v0
    v_add3_u32 v101, v101, v102, s62
    v_lshlrev_b32 v102, 11, v102
    v_lshl_add_u32 v102, v100, 4, v102
    s_lshl_b32 s44, s5, 18
    s_lshl_b32 s45, s6, 8
    s_add_u32 s44, s44, s45
    s_lshl_b32 s45, s61, 6
    s_add_u32 s44, s44, s45
    s_add_u32 s44, s44, 0x200000
    s_add_u32 s45, s44, 0x20000
    s_lshl_b32 s39, s5, 9
    s_lshl_b32 s46, s6, 4
    s_add_u32 s39, s39, s46
    s_lshl_b32 s46, s61, 2
    s_add_u32 s39, s39, s46
    s_add_u32 s39, s39, 0x8000
    s_setprio 3
    s_waitcnt vmcnt(1)
    ds_read2_b32 v[40:41], v101 offset0:0 offset1:32
    ds_read2_b32 v[42:43], v101 offset0:64 offset1:96
    ds_read2_b32 v[44:45], v101 offset0:16 offset1:48
    ds_read2_b32 v[46:47], v101 offset0:80 offset1:112
    v_mov_b32 v24, 0
    v_mov_b32 v25, 0
    v_lshlrev_b32 v103, 3, v0
    v_bfe_u32 v104, v0, 2, 1
    v_mul_u32_u24 v104, 11488, v104
    v_lshl_add_u32 v104, v100, 3, v104
    s_waitcnt lgkmcnt(2)
    buffer_store_dwordx4 v[40:43], v102, s[12:15], s44 offen
    s_waitcnt lgkmcnt(0)
    buffer_store_dwordx4 v[44:47], v102, s[12:15], s45 offen
    s_cmp_lg_u32 s4, 4
    s_cbranch_scc1 L_E_X
    ds_write_b64 v103, v[24:25]
    ds_write_b64 v103, v[24:25] offset:4608
    ds_write_b64 v104, v[24:25] offset:22528
    ds_write_b64 v104, v[24:25] offset:25984
    ds_write_b64 v104, v[24:25] offset:29440
    ds_write_b64 v104, v[24:25] offset:31792
    s_branch L_E_X
L_EF_T:
    s_sub_u32 s3, s3, 1
    s_cbranch_scc1 L_END
    ds_read_b32 v35, v37 offset:12
    s_waitcnt lgkmcnt(0)
    v_readfirstlane_b32 s8, v35
    v_cmp_eq_u32 vcc, 0, v35
    s_cbranch_vccnz L_EF_T
    v_xor_b32 v35, s74, v35
    s_waitcnt vmcnt(0)
    s_mov_b64 exec, 1
    buffer_store_dword v35, off, s[12:15], s39
    s_mov_b64 exec, -1
    s_setprio 1
    s_branch L_E_X3
L_F0:
    s_mov_b32 s20, s50
    s_mov_b32 s21, s51
    s_mov_b32 s22, 1409024
    s_mov_b32 s40, s52
    s_mov_b32 s41, s53
    s_mov_b32 s42, 1409024
    s_mov_b32 s43, 0x00020000
    s_mov_b32 s44, s54
    s_mov_b32 s45, s55
    s_mov_b32 s46, 1409024
    s_mov_b32 s47, 0x00020000
    s_movk_i32 s28, 171
    s_movk_i32 s29, 2656
    v_add_u32 v128, 0, v0
    v_mul_u32_u24 v5, s28, v128
    v_lshrrev_b32 v5, 10, v5
    v_lshlrev_b32 v128, 4, v128
    v_mad_u32_u24 v128, v5, s29, v128
    v_add_u32 v129, 64, v0
    v_mul_u32_u24 v5, s28, v129
    v_lshrrev_b32 v5, 10, v5
    v_lshlrev_b32 v129, 4, v129
    v_mad_u32_u24 v129, v5, s29, v129
    v_add_u32 v130, 128, v0
    v_mul_u32_u24 v5, s28, v130
    v_lshrrev_b32 v5, 10, v5
    v_lshlrev_b32 v130, 4, v130
    v_mad_u32_u24 v130, v5, s29, v130
    s_mul_i32 s36, s5, 176128
    s_mul_i32 s37, s6, 96
    s_add_u32 s36, s36, s37
    s_add_u32 s37, s36, 88064
L_F_KW:
    s_sub_u32 s3, s3, 1
    s_cbranch_scc1 L_END
    ds_read_b32 v6, v37 offset:8
    s_waitcnt lgkmcnt(0)
    v_cmp_ne_u32 vcc, 5, v6
    s_cbranch_vccnz L_F_KW
    s_mov_b32 m0, 113088
    s_nop 0
    buffer_load_dwordx4 v128, s[20:23], s36 offen lds
    s_mov_b32 m0, 114112
    s_nop 0
    buffer_load_dwordx4 v129, s[20:23], s36 offen lds
    s_mov_b32 m0, 115136
    s_nop 0
    buffer_load_dwordx4 v130, s[20:23], s36 offen lds
    s_mov_b32 m0, 116160
    s_nop 0
    buffer_load_dwordx4 v128, s[20:23], s37 offen lds
    s_mov_b32 m0, 117184
    s_nop 0
    buffer_load_dwordx4 v129, s[20:23], s37 offen lds
    s_mov_b32 m0, 118208
    s_nop 0
    buffer_load_dwordx4 v130, s[20:23], s37 offen lds
    v_and_b32 v131, 0x380, v1
    v_and_b32 v5, 0x70, v1
    v_lshl_add_u32 v131, v131, 3, v5
    s_mul_i32 s38, s6, 49152
    s_lshl_b32 s31, s5, 7
    s_add_u32 s38, s38, s31
    v_lshrrev_b32 v5, 4, v0
    v_bfe_u32 v6, v0, 2, 2
    v_and_b32 v7, 3, v0
    v_lshl_add_u32 v152, v5, 3, v6
    v_mul_u32_u24 v153, 96, v152
    v_lshl_add_u32 v153, v7, 3, v153
    v_add_u32 v153, 113088, v153
    v_lshlrev_b32 v154, 7, v152
    v_lshl_add_u32 v154, v7, 3, v154
    v_add_u32 v154, 125376, v154
    v_lshl_add_u32 v155, v5, 2, v6
    v_lshlrev_b32 v155, 7, v155
    v_lshl_add_u32 v155, v7, 3, v155
    v_add_u32 v155, 129472, v155
    v_lshlrev_b32 v13, 2, v0
    v_add_u32 v13, 139712, v13
    v_and_b32 v14, 4, v0
    v_lshlrev_b32 v14, 5, v14
    v_and_b32 v15, 48, v0
    v_add_u32 v14, v14, v15
    v_add_u32 v14, 139712, v14
    s_lshl_b32 s60, s6, 13
    s_add_u32 s60, s60, 0x40000
    s_add_u32 s61, s60, 4096
    s_lshl_b32 s34, s5, 10
    s_add_u32 s34, s34, s60
    v_and_b32 v2, 31, v0
    v_lshlrev_b32 v2, 2, v2
    v_and_b32 v3, 7, v0
    v_lshlrev_b32 v3, 2, v3
    v_mov_b32 v159, s8
    v_lshlrev_b32 v4, 2, v0
    s_lshl_b32 s10, s5, 9
    s_add_u32 s10, s10, 0x8100
    s_xor_b32 s74, s74, s8
    s_mov_b32 s28, 30
L_F_TR:
    s_sub_u32 s28, s28, 1
    s_cbranch_scc1 L_F_TRD
    buffer_load_dword v5, v4, s[12:15], s10 offen sc1
    s_waitcnt vmcnt(0)
    v_cmp_ne_u32 vcc, s74, v5
    s_cbranch_vccnz L_F_TR
L_F_TRD:
    s_mov_b32 s10, 0x14000
    buffer_load_dwordx4 v[56:59], v1, s[12:15], s10 offen sc1
    buffer_load_dwordx4 v[60:63], v1, s[12:15], s10 offen offset:1024 sc1
    buffer_load_dwordx4 v[64:67], v1, s[12:15], s10 offen offset:2048 sc1
    buffer_load_dwordx4 v[68:71], v1, s[12:15], s10 offen offset:3072 sc1
    s_mov_b32 m0, 119232
    s_nop 0
    buffer_load_dwordx4 v128, s[40:43], s36 offen lds
    s_mov_b32 m0, 120256
    s_nop 0
    buffer_load_dwordx4 v129, s[40:43], s36 offen lds
    s_mov_b32 m0, 121280
    s_nop 0
    buffer_load_dwordx4 v130, s[40:43], s36 offen lds
    s_mov_b32 m0, 122304
    s_nop 0
    buffer_load_dwordx4 v128, s[40:43], s37 offen lds
    s_mov_b32 m0, 123328
    s_nop 0
    buffer_load_dwordx4 v129, s[40:43], s37 offen lds
    s_mov_b32 m0, 124352
    s_nop 0
    buffer_load_dwordx4 v130, s[40:43], s37 offen lds
    ds_read_b64_tr_b16 v[80:81], v153 offset:0
    ds_read_b64_tr_b16 v[82:83], v153 offset:384
    ds_read_b64_tr_b16 v[84:85], v153 offset:3072
    ds_read_b64_tr_b16 v[86:87], v153 offset:3456
    ds_read_b64_tr_b16 v[88:89], v153 offset:32
    ds_read_b64_tr_b16 v[90:91], v153 offset:416
    ds_read_b64_tr_b16 v[92:93], v153 offset:3104
    ds_read_b64_tr_b16 v[94:95], v153 offset:3488
    ds_read_b64_tr_b16 v[96:97], v153 offset:64
    ds_read_b64_tr_b16 v[98:99], v153 offset:448
    ds_read_b64_tr_b16 v[100:101], v153 offset:3136
    ds_read_b64_tr_b16 v[102:103], v153 offset:3520
    s_waitcnt lgkmcnt(0)
    s_waitcnt vmcnt(6)
L_K_CHK:
    v_xor_b32 v58, s8, v58
    v_xor_b32 v62, s8, v62
    v_xor_b32 v66, s8, v66
    v_xor_b32 v70, s8, v70
    v_or3_b32 v58, v58, v62, v66
    v_or_b32 v58, v58, v70
    v_cmp_ne_u32 vcc, 0, v58
    s_cbranch_vccnz L_K_POLL_B
    s_setprio 3
    ds_bpermute_b32 v62, v3, v59
    v_max_u32 v57, v57, v61
    v_med3_u32 v57, v56, v60, v57
    v_max_u32 v56, v56, v60
    v_max_u32 v65, v65, v69
    v_med3_u32 v65, v64, v68, v65
    v_max_u32 v64, v64, v68
    v_max_u32 v57, v57, v65
    v_med3_u32 v57, v56, v64, v57
    v_max_u32 v56, v56, v64
    v_xor_b32 v63, v59, v63
    v_xor_b32 v67, v59, v67
    v_mov_b32_dpp v58, v56 row_ror:8 row_mask:0xf bank_mask:0xf
    v_max_u32_dpp v57, v57, v57 row_ror:8 row_mask:0xf bank_mask:0xf
    v_med3_u32 v57, v56, v58, v57
    v_max_u32 v56, v56, v58
    v_xor_b32 v71, v59, v71
    s_nop 0
    v_mov_b32_dpp v58, v56 row_ror:4 row_mask:0xf bank_mask:0xf
    v_max_u32_dpp v57, v57, v57 row_ror:4 row_mask:0xf bank_mask:0xf
    v_med3_u32 v57, v56, v58, v57
    v_max_u32 v56, v56, v58
    v_or3_b32 v63, v63, v67, v71
    s_nop 0
    v_mov_b32_dpp v58, v56 row_ror:2 row_mask:0xf bank_mask:0xf
    v_max_u32_dpp v57, v57, v57 row_ror:2 row_mask:0xf bank_mask:0xf
    v_med3_u32 v57, v56, v58, v57
    v_max_u32 v56, v56, v58
    s_nop 1
    v_mov_b32_dpp v58, v56 row_ror:1 row_mask:0xf bank_mask:0xf
    v_max_u32_dpp v57, v57, v57 row_ror:1 row_mask:0xf bank_mask:0xf
    v_med3_u32 v57, v56, v58, v57
    v_max_u32 v56, v56, v58
    v_cmp_gt_u32 vcc, 32, v0
    v_readlane_b32 s66, v56, 0
    v_readlane_b32 s67, v57, 0
    v_readlane_b32 s68, v56, 16
    v_readlane_b32 s69, v57, 16
    v_readlane_b32 s70, v56, 32
    v_readlane_b32 s71, v57, 32
    v_readlane_b32 s72, v56, 48
    v_readlane_b32 s73, v57, 48
    s_max_u32 s67, s67, s69
    s_min_u32 s69, s66, s68
    s_max_u32 s67, s67, s69
    s_max_u32 s66, s66, s68
    s_max_u32 s71, s71, s73
    s_min_u32 s73, s70, s72
    s_max_u32 s71, s71, s73
    s_max_u32 s70, s70, s72
    s_max_u32 s67, s67, s71
    s_min_u32 s71, s66, s70
    s_max_u32 s67, s67, s71
    s_max_u32 s66, s66, s70
    v_mov_b32 v56, s66
    v_mov_b32 v57, s67
    v_cndmask_b32 v4, v57, v56, vcc
    v_and_b32 v4, 0x7ff, v4
    v_sub_u32 v4, 2047, v4
    v_lshl_add_u32 v5, v4, 10, v2
    buffer_load_dword v156, v5, s[16:19], s31 offen
    v_lshrrev_b32 v157, 8, v4
    v_lshlrev_b32 v157, 11, v157
    v_bfe_u32 v5, v4, 1, 1
    v_lshl_add_u32 v157, v5, 10, v157
    v_bfe_u32 v5, v4, 2, 6
    v_lshl_add_u32 v157, v5, 4, v157
    s_mov_b32 s10, 0x10000
    buffer_load_dwordx4 v[160:163], v157, s[12:15], s10 offen sc1
    s_waitcnt lgkmcnt(0)
    v_xor_b32 v62, v62, v59
    v_or_b32 v62, v62, v63
    v_cmp_ne_u32 vcc, 0, v62
    v_mov_b32 v58, 144528
    s_cmp_eq_u64 vcc, 0
    s_cselect_b32 s62, 16384, 0
    s_or_b32 s66, s66, s62
    s_or_b32 s66, s66, 0x8000
    v_mov_b32 v56, s66
    v_mov_b32 v10, 0
    s_mov_b64 exec, 1
    ds_write_b64 v58, v[56:57]
    s_mov_b64 exec, -1
    v_and_b32 v5, 1, v0
    v_cmp_eq_u32 vcc, 0, v5
    v_and_b32 v4, 1, v4
    v_lshrrev_b32 v5, 5, v0
    v_cndmask_b32 v64, v57, v56, vcc
    v_and_b32 v65, 0x7ff, v64
    v_sub_u32 v65, 2047, v65
    v_lshlrev_b32 v66, 10, v65
    v_lshl_add_u32 v66, v5, 1, v66
    buffer_load_ushort v67, v66, s[16:19], s58 offen
    v_mul_u32_u24 v68, 4608, v5
    v_lshl_add_u32 v68, v65, 1, v68
    v_lshrrev_b32 v7, 8, v65
    v_bfe_u32 v8, v0, 1, 2
    v_lshl_add_u32 v69, v7, 2, v8
    v_lshlrev_b32 v69, 2, v69
    v_add_u32 v69, 144320, v69
    v_lshlrev_b32 v70, 2, v7
    v_add_u32 v70, 144448, v70
    v_mul_u32_u24 v71, 33792, v5
    v_lshl_add_u32 v71, v7, 11, v71
    v_bfe_u32 v8, v65, 2, 2
    v_bfe_u32 v9, v65, 4, 4
    v_lshl_add_u32 v9, v8, 2, v9
    v_and_b32 v9, 15, v9
    v_lshl_add_u32 v9, v8, 4, v9
    v_lshl_add_u32 v71, v9, 4, v71
    v_and_b32 v8, 3, v65
    v_lshl_add_u32 v71, v8, 2, v71
    v_add_u32 v71, 45504, v71
    s_cmp_ge_u32 s6, 29
    s_cbranch_scc1 L_F_P2
    s_waitcnt vmcnt(3)
    ds_read_b64_tr_b16 v[104:105], v153 offset:6144
    ds_read_b64_tr_b16 v[106:107], v153 offset:6528
    ds_read_b64_tr_b16 v[108:109], v153 offset:9216
    ds_read_b64_tr_b16 v[110:111], v153 offset:9600
    ds_read_b64_tr_b16 v[112:113], v153 offset:6176
    ds_read_b64_tr_b16 v[114:115], v153 offset:6560
    ds_read_b64_tr_b16 v[116:117], v153 offset:9248
    ds_read_b64_tr_b16 v[118:119], v153 offset:9632
    ds_read_b64_tr_b16 v[120:121], v153 offset:6208
    ds_read_b64_tr_b16 v[122:123], v153 offset:6592
    ds_read_b64_tr_b16 v[124:125], v153 offset:9280
    ds_read_b64_tr_b16 v[126:127], v153 offset:9664
    s_waitcnt vmcnt(1)
    v_cmp_ne_u32 vcc, s8, v163
    s_cbranch_vccnz L_F_SR
L_F_SOK:
    v_cmp_eq_u32 vcc, 1, v4
    v_lshlrev_b32 v20, 16, v156
    v_and_b32 v21, s9, v156
    v_cndmask_b32 v16, v160, v161, vcc
    v_and_b32 v18, s9, v16
    v_lshlrev_b32 v16, 16, v16
    v_rcp_f32 v18, v18
    v_sub_f32 v20, v20, v16
    v_sub_f32 v21, v21, v16
    v_cvt_pk_bf16_f32 v21, v20, v21
    v_lshlrev_b32 v20, 16, v21
    v_and_b32 v21, s9, v21
    v_mul_f32 v20, v20, v18
    v_mul_f32 v21, v21, v18
    v_cvt_pk_bf16_f32 v20, v20, v21
    ds_write_b32 v13, v20
    ds_read_b128 v[16:19], v14
    ds_read_b128 v[20:23], v14 offset:64
    v_cmp_gt_u32 vcc, 32, v0
    s_waitcnt lgkmcnt(1)
    v_mfma_f32_16x16x32_bf16 v[24:27], v[16:19], v[80:83], 0
    v_mfma_f32_16x16x32_bf16 v[28:31], v[16:19], v[88:91], 0
    v_mfma_f32_16x16x32_bf16 v[32:35], v[16:19], v[96:99], 0
    v_mfma_f32_16x16x32_bf16 v[36:39], v[16:19], v[104:107], 0
    v_mfma_f32_16x16x32_bf16 v[40:43], v[16:19], v[112:115], 0
    v_mfma_f32_16x16x32_bf16 v[44:47], v[16:19], v[120:123], 0
    s_waitcnt lgkmcnt(0)
    v_mfma_f32_16x16x32_bf16 v[24:27], v[20:23], v[84:87], v[24:27]
    v_mfma_f32_16x16x32_bf16 v[28:31], v[20:23], v[92:95], v[28:31]
    v_mfma_f32_16x16x32_bf16 v[32:35], v[20:23], v[100:103], v[32:35]
    v_mfma_f32_16x16x32_bf16 v[36:39], v[20:23], v[108:111], v[36:39]
    v_mfma_f32_16x16x32_bf16 v[40:43], v[20:23], v[116:119], v[40:43]
    v_mfma_f32_16x16x32_bf16 v[44:47], v[20:23], v[124:127], v[44:47]
    s_nop 5
    v_cndmask_b32 v156, v36, v24, vcc
    v_cndmask_b32 v157, v40, v28, vcc
    v_cndmask_b32 v158, v44, v32, vcc
    buffer_store_dwordx4 v[156:159], v1, s[12:15], s34 offen sc1
    s_setprio 1
    s_mov_b32 m0, 125376
    s_nop 0
    buffer_load_dwordx4 v131, s[44:47], s38 offen lds
    s_mov_b32 m0, 126400
    s_add_u32 s38, s38, 8192
    buffer_load_dwordx4 v131, s[44:47], s38 offen lds
    s_mov_b32 m0, 127424
    s_add_u32 s38, s38, 8192
    buffer_load_dwordx4 v131, s[44:47], s38 offen lds
    s_mov_b32 m0, 128448
    s_add_u32 s38, s38, 8192
    buffer_load_dwordx4 v131, s[44:47], s38 offen lds
    s_mov_b32 m0, 129472
    s_add_u32 s38, s38, 8192
    buffer_load_dwordx4 v131, s[44:47], s38 offen lds
    s_mov_b32 m0, 130496
    s_add_u32 s38, s38, 8192
    buffer_load_dwordx4 v131, s[44:47], s38 offen lds
L_F_P2:
    s_cmp_lg_u32 s2, 0
    s_cbranch_scc1 L_F_NE
    s_mov_b64 exec, 1
    buffer_store_dword v159, v10, s[12:15], 0 offen
    s_mov_b64 exec, -1
L_F_NE:
    v_ashrrev_i32 v8, 31, v64
    v_not_b32 v8, v8
    v_or_b32 v8, 0x80000000, v8
    v_xor_b32 v6, v64, v8
    v_and_b32 v6, s9, v6
    v_mul_f32 v6, 0xbfb8aa3b, v6
    v_exp_f32 v6, v6
    v_lshlrev_b32 v8, 4, v5
    v_add_f32 v6, 1.0, v6
    v_rcp_f32 v6, v6
    v_lshrrev_b32 v72, v8, s59
    v_cmp_gt_u32 s[64:65], 58, v0
    v_cvt_pk_bf16_f32 v6, v6, v6
    v_lshlrev_b32 v72, 16, v72
    v_lshlrev_b32 v73, 16, v6
    s_mov_b32 s24, 0x0c0c0400
    s_mov_b32 s25, 0x04000c0c
    s_mov_b32 s28, 0xffffff00
    s_bitcmp1_b32 s6, 0
    s_cselect_b64 s[66:67], -1, 0
    s_cmp_eq_u32 s62, 0
    s_cselect_b32 s29, 0x20000, 0
    s_lshl_b32 s35, s5, 14
    s_add_u32 s35, s35, s29
    s_add_u32 s35, s35, 0x80000
    s_lshr_b32 s26, s6, 1
    s_lshl_b32 s26, s26, 10
    s_add_u32 s26, s26, s35
    s_lshl_b32 s29, s6, 5
    s_add_u32 s35, s35, s29
    s_mov_b32 s20, s56
    s_mov_b32 s21, s57
    s_mov_b32 s22, 0x200000
    s_cmp_ge_u32 s6, 29
    s_cbranch_scc1 L_F_POLL
    v_and_b32 v112, 15, v0
    v_lshlrev_b32 v112, 1, v112
    v_and_b32 v113, 16, v0
    v_lshl_add_u32 v112, v113, 3, v112
    v_add_u32 v112, 139712, v112
    v_and_b32 v113, 1, v0
    v_lshlrev_b32 v113, 7, v113
    v_and_b32 v114, 48, v0
    v_lshrrev_b32 v115, 1, v114
    v_add_u32 v113, 139712, v113
    v_add_u32 v114, v113, v114
    v_add_u32 v115, v113, v115
    v_bfe_u32 v116, v0, 1, 2
    v_lshrrev_b32 v117, 4, v0
    v_lshl_add_u32 v117, v116, 2, v117
    v_lshlrev_b32 v117, 10, v117
    v_and_b32 v118, 1, v0
    v_lshl_add_u32 v117, v118, 4, v117
    v_cmp_eq_u32 s[68:69], 1, v116
    v_cmp_eq_u32 s[70:71], 2, v116
    v_cmp_eq_u32 s[72:73], 3, v116
    s_and_b32 s36, s8, 0xff
    s_bfe_u32 s37, s8, 0x80008
    s_bfe_u32 s38, s8, 0x80010
    s_lshr_b32 s39, s8, 24
    v_mov_b32 v118, 0xffffff00
    s_waitcnt vmcnt(0)
    ds_read_b64_tr_b16 v[128:129], v154 offset:0
    ds_read_b64_tr_b16 v[130:131], v154 offset:512
    ds_read_b64_tr_b16 v[132:133], v155 offset:0
    ds_read_b64_tr_b16 v[134:135], v154 offset:32
    ds_read_b64_tr_b16 v[136:137], v154 offset:544
    ds_read_b64_tr_b16 v[138:139], v155 offset:32
    ds_read_b64_tr_b16 v[140:141], v154 offset:64
    ds_read_b64_tr_b16 v[142:143], v154 offset:576
    ds_read_b64_tr_b16 v[144:145], v155 offset:64
    ds_read_b64_tr_b16 v[146:147], v154 offset:96
    ds_read_b64_tr_b16 v[148:149], v154 offset:608
    ds_read_b64_tr_b16 v[150:151], v155 offset:96
L_F_PA:
    s_sub_u32 s3, s3, 20
    s_cbranch_scc1 L_END
    buffer_load_dwordx4 v[80:83], v1, s[12:15], s60 offen offset:0 sc1
    buffer_load_dwordx4 v[84:87], v1, s[12:15], s60 offen offset:1024 sc1
    buffer_load_dwordx4 v[88:91], v1, s[12:15], s60 offen offset:2048 sc1
    buffer_load_dwordx4 v[92:95], v1, s[12:15], s60 offen offset:3072 sc1
    buffer_load_dwordx4 v[96:99], v1, s[12:15], s61 offen offset:0 sc1
    buffer_load_dwordx4 v[100:103], v1, s[12:15], s61 offen offset:1024 sc1
    buffer_load_dwordx4 v[104:107], v1, s[12:15], s61 offen offset:2048 sc1
    buffer_load_dwordx4 v[108:111], v1, s[12:15], s61 offen offset:3072 sc1
    s_waitcnt vmcnt(0) lgkmcnt(0)
    v_xor_b32 v83, s8, v83
    v_xor_b32 v87, s8, v87
    v_xor_b32 v91, s8, v91
    v_xor_b32 v95, s8, v95
    v_xor_b32 v99, s8, v99
    v_xor_b32 v103, s8, v103
    v_xor_b32 v107, s8, v107
    v_xor_b32 v111, s8, v111
    v_or3_b32 v83, v83, v87, v91
    v_or3_b32 v95, v95, v99, v103
    v_or3_b32 v83, v83, v107, v111
    v_or_b32 v83, v83, v95
    v_cmp_ne_u32 vcc, 0, v83
    s_cbranch_vccnz L_F_PA_B
    s_setprio 3
    v_add_f32 v80, v80, v96
    v_add_f32 v81, v81, v97
    v_add_f32 v82, v82, v98
    v_add_f32 v84, v84, v100
    v_add_f32 v85, v85, v101
    v_add_f32 v86, v86, v102
    v_add_f32 v88, v88, v104
    v_add_f32 v89, v89, v105
    v_add_f32 v90, v90, v106
    v_add_f32 v92, v92, v108
    v_add_f32 v93, v93, v109
    v_add_f32 v94, v94, v110
    v_add_f32 v80, v80, v88
    v_add_f32 v81, v81, v89
    v_add_f32 v82, v82, v90
    v_add_f32 v84, v84, v92
    v_add_f32 v85, v85, v93
    v_add_f32 v86, v86, v94
    v_add_f32 v80, v80, v84
    v_add_f32 v81, v81, v85
    v_add_f32 v82, v82, v86
    v_mov_b32 v84, v80
    v_mov_b32 v85, v81
    v_mov_b32 v86, v82
    s_nop 0
    v_permlane32_swap_b32 v80, v84
    v_permlane32_swap_b32 v81, v85
    v_permlane32_swap_b32 v82, v86
    s_nop 0
    v_cvt_pk_bf16_f32 v84, v80, v84
    v_cvt_pk_bf16_f32 v85, v81, v85
    v_cvt_pk_bf16_f32 v86, v82, v86
    v_lshlrev_b32 v80, 16, v84
    v_lshlrev_b32 v81, 16, v85
    v_lshlrev_b32 v82, 16, v86
    v_mul_f32 v88, 0xbfb8aa3b, v80
    v_mul_f32 v89, 0xbfb8aa3b, v81
    v_mul_f32 v90, 0xbfb8aa3b, v82
    v_exp_f32 v88, v88
    v_exp_f32 v89, v89
    v_exp_f32 v90, v90
    v_and_b32 v84, s9, v84
    v_and_b32 v85, s9, v85
    v_and_b32 v86, s9, v86
    v_add_f32 v88, 1.0, v88
    v_add_f32 v89, 1.0, v89
    v_add_f32 v90, 1.0, v90
    v_rcp_f32 v88, v88
    v_rcp_f32 v89, v89
    v_rcp_f32 v90, v90
    s_nop 0
    v_mul_f32 v80, v80, v88
    v_mul_f32 v81, v81, v89
    v_mul_f32 v82, v82, v90
    v_cvt_pk_bf16_f32 v80, v80, v80
    v_cvt_pk_bf16_f32 v81, v81, v81
    v_cvt_pk_bf16_f32 v82, v82, v82
    v_lshlrev_b32 v80, 16, v80
    v_lshlrev_b32 v81, 16, v81
    v_lshlrev_b32 v82, 16, v82
    v_mul_f32 v80, v80, v84
    v_mul_f32 v81, v81, v85
    v_mul_f32 v82, v82, v86
    v_cvt_pk_bf16_f32 v80, v80, v80
    ds_write_b16 v112, v80 offset:0
    v_cvt_pk_bf16_f32 v81, v81, v81
    ds_write_b16 v112, v81 offset:32
    v_cvt_pk_bf16_f32 v82, v82, v82
    ds_write_b16 v112, v82 offset:64
    ds_read_b128 v[88:91], v114
    ds_read_b64 v[92:93], v115 offset:64
    s_waitcnt lgkmcnt(1)
    v_mfma_f32_16x16x32_bf16 v[96:99], v[128:131], v[88:91], 0
    v_mfma_f32_16x16x32_bf16 v[100:103], v[134:137], v[88:91], 0
    v_mfma_f32_16x16x32_bf16 v[104:107], v[140:143], v[88:91], 0
    v_mfma_f32_16x16x32_bf16 v[108:111], v[146:149], v[88:91], 0
    s_waitcnt lgkmcnt(0)
    s_nop 2
    v_mfma_f32_16x16x16_bf16 v[96:99], v[132:133], v[92:93], v[96:99]
    v_mfma_f32_16x16x16_bf16 v[100:103], v[138:139], v[92:93], v[100:103]
    v_mfma_f32_16x16x16_bf16 v[104:107], v[144:145], v[92:93], v[104:107]
    v_mfma_f32_16x16x16_bf16 v[108:111], v[150:151], v[92:93], v[108:111]
    s_mov_b32 s40, 0x00ff00ff
    s_mov_b32 s41, 0x00ff00ff
    s_cmp_eq_u32 s62, 0
    s_nop 2
    v_cndmask_b32 v96, v96, v100, s[68:69]
    v_cndmask_b32 v97, v97, v101, s[68:69]
    v_cndmask_b32 v98, v98, v102, s[68:69]
    v_cndmask_b32 v99, v99, v103, s[68:69]
    v_cndmask_b32 v96, v96, v104, s[70:71]
    v_cndmask_b32 v97, v97, v105, s[70:71]
    v_cndmask_b32 v98, v98, v106, s[70:71]
    v_cndmask_b32 v99, v99, v107, s[70:71]
    v_cndmask_b32 v96, v96, v108, s[72:73]
    v_cndmask_b32 v97, v97, v109, s[72:73]
    v_cndmask_b32 v98, v98, v110, s[72:73]
    v_cndmask_b32 v99, v99, v111, s[72:73]
    v_and_or_b32 v96, v96, v118, s36
    v_and_or_b32 v97, v97, v118, s37
    v_and_or_b32 v98, v98, v118, s38
    v_and_or_b32 v99, v99, v118, s39
    s_mov_b64 exec, s[40:41]
    s_cbranch_scc1 L_F_PBG
    buffer_store_dwordx4 v[96:99], v117, s[12:15], s35 offen
L_F_PBD:
    s_mov_b64 exec, -1
    s_setprio 1
L_F_POLL:
    s_sub_u32 s3, s3, 10
    s_cbranch_scc1 L_END
    s_sleep 1
    buffer_load_dwordx4 v[8:11], v1, s[12:15], s26 offen sc1
    ds_read_b32 v20, v70
    ds_read_u16 v24, v68 offset:512
    s_waitcnt vmcnt(0) lgkmcnt(0)
    v_perm_b32 v16, v9, v8, s24
    v_perm_b32 v17, v11, v10, s25
    v_or_b32 v16, v16, v17
    v_cmp_ne_u32 vcc, s8, v16
    v_cmp_eq_u32 s[30:31], 0, v20
    s_and_b64 vcc, vcc, s[64:65]
    s_or_b64 vcc, vcc, s[30:31]
    s_cbranch_vccnz L_F_POLL
    s_setprio 3
    v_cndmask_b32 v8, v8, v10, s[66:67]
    v_cndmask_b32 v9, v9, v11, s[66:67]
    v_and_b32 v8, s28, v8
    v_and_b32 v9, s28, v9
    v_cndmask_b32 v8, 0, v8, s[64:65]
    v_cndmask_b32 v9, 0, v9, s[64:65]
    v_lshlrev_b32 v67, 16, v67
    v_lshlrev_b32 v24, 16, v24
    v_permlane32_swap_b32 v8, v9
    v_mul_f32 v25, v24, v72
    v_add_f32 v8, v8, v9
    v_mov_b32 v9, v8
    s_nop 1
    v_permlane16_swap_b32 v8, v9
    s_nop 0
    v_add_f32 v8, v8, v9
    s_nop 1
    v_add_f32_dpp v8, v8, v8 row_ror:8 row_mask:0xf bank_mask:0xf
    s_nop 1
    v_add_f32_dpp v8, v8, v8 row_ror:4 row_mask:0xf bank_mask:0xf
    s_nop 1
    v_add_f32_dpp v8, v8, v8 row_ror:2 row_mask:0xf bank_mask:0xf
    ds_read_b32 v20, v69
    ds_read_b32 v26, v71
    ds_read_b32 v27, v71 offset:1024
    v_cvt_pk_bf16_f32 v8, v8, v8
    v_lshlrev_b32 v8, 16, v8
    v_mul_f32 v8, v8, v73
    v_cvt_pk_bf16_f32 v8, v8, v8
    v_lshlrev_b32 v8, 16, v8
    v_add_f32 v8, v8, v24
    v_cvt_pk_bf16_f32 v8, v8, v8
    v_lshlrev_b32 v8, 16, v8
    v_mul_f32 v9, 0xbfb8aa3b, v8
    v_exp_f32 v9, v9
    s_mov_b32 s24, 3
    v_add_f32 v9, 1.0, v9
    v_rcp_f32 v9, v9
    s_mov_b32 s25, 3
    v_mul_f32 v8, v8, v9
    v_fma_f32 v25, v25, v8, v67
    s_waitcnt lgkmcnt(0)
    v_cmp_eq_u32 vcc, 0, v20
    s_cbranch_vccnz L_F_SPY
L_F_FIN:
    v_add_f32 v26, v26, v27
    v_fma_f32 v8, v8, v26, v25
    v_cvt_pk_bf16_f32 v8, v8, v8
    s_mov_b64 exec, s[24:25]
    buffer_store_short v8, v66, s[20:23], s58 offen
    s_endpgm
L_F_SPY:
    s_setprio 0
L_F_SPY2:
    s_sub_u32 s3, s3, 1
    s_cbranch_scc1 L_END
    s_sleep 1
    ds_read_b32 v20, v69
    ds_read_b32 v26, v71
    ds_read_b32 v27, v71 offset:1024
    s_waitcnt lgkmcnt(0)
    v_cmp_eq_u32 vcc, 0, v20
    s_cbranch_vccnz L_F_SPY2
    s_branch L_F_FIN
L_K_POLL:
    s_sub_u32 s3, s3, 20
    s_cbranch_scc1 L_END
    buffer_load_dwordx4 v[56:59], v1, s[12:15], s10 offen sc1
    buffer_load_dwordx4 v[60:63], v1, s[12:15], s10 offen offset:1024 sc1
    buffer_load_dwordx4 v[64:67], v1, s[12:15], s10 offen offset:2048 sc1
    buffer_load_dwordx4 v[68:71], v1, s[12:15], s10 offen offset:3072 sc1
    s_waitcnt vmcnt(0)
    s_branch L_K_CHK
L_F_SR:
    s_sub_u32 s3, s3, 20
    s_cbranch_scc1 L_END
    s_sleep 4
    buffer_load_dwordx4 v[160:163], v157, s[12:15], s10 offen sc1
    s_waitcnt vmcnt(0)
    v_cmp_ne_u32 vcc, s8, v163
    s_cbranch_vccnz L_F_SR
    s_branch L_F_SOK
L_F_PBG:
    buffer_store_dwordx4 v[96:99], v117, s[12:15], s35 offen sc1
    s_branch L_F_PBD
L_M:
    s_setprio 2
    s_mov_b32 s9, 0xffff0000
    s_mov_b32 s70, 0x3fb8aa3b
    s_and_b32 s61, s4, 1
    s_mov_b32 s72, 0x3e22f983
    s_mov_b32 s71, 0xbe22f983
    s_cmp_eq_u32 s61, 0
    s_cselect_b32 s72, s71, s72
    s_mov_b32 s71, 0x41000000
    s_cselect_b32 s71, 1.0, s71
    s_waitcnt vmcnt(2)
    v_lshlrev_b32 v9, 16, v3
    v_lshlrev_b32 v10, 16, v4
    v_and_b32 v11, s9, v4
    v_mul_f32 v9, s70, v9
    v_mul_f32 v10, s70, v10
    v_mul_f32 v11, s70, v11
    v_exp_f32 v9, v9
    v_exp_f32 v10, v10
    v_exp_f32 v11, v11
    v_lshlrev_b32 v12, 16, v5
    v_and_b32 v13, s9, v5
    v_cvt_pk_bf16_f32 v9, v9, v9
    v_cvt_pk_bf16_f32 v10, v10, v11
    v_lshlrev_b32 v9, 16, v9
    v_and_b32 v11, s9, v10
    v_lshlrev_b32 v10, 16, v10
    v_mul_f32 v12, v12, v9
    v_mul_f32 v13, v13, v9
    v_mul_f32 v10, v10, v9
    v_mul_f32 v11, v11, v9
    v_mul_f32 v12, s72, v12
    v_mul_f32 v13, s72, v13
    v_mul_f32 v10, 0xbfb8aa3b, v10
    v_mul_f32 v11, 0xbfb8aa3b, v11
    s_mul_i32 s63, s60, 33792
    s_add_u32 s63, s63, 45504
    v_lshl_add_u32 v8, v0, 3, s63
    v_mul_f32 v14, s71, v10
    v_mul_f32 v15, s71, v11
    v_mul_f32 v16, s71, v12
    v_mul_f32 v17, s71, v13
    v_exp_f32 v14, v14
    v_exp_f32 v15, v15
    v_fract_f32 v16, v16
    v_fract_f32 v17, v17
    v_cos_f32 v32, v16
    v_sin_f32 v33, v16
    v_cos_f32 v34, v17
    v_sin_f32 v35, v17
    v_mul_f32 v32, v32, v14
    v_mul_f32 v33, v33, v14
    v_mul_f32 v34, v34, v15
    v_mul_f32 v35, v35, v15
    s_cmp_eq_u32 s61, 0
    s_cbranch_scc1 L_M_ALPHA
    v_mov_b32 v24, 0x3f80
    v_mov_b32 v25, 0x3f80
    ds_write_b64 v8, v[24:25] offset:16896
    v_cvt_pk_bf16_f32 v26, v32, v33
    v_cvt_pk_bf16_f32 v27, v34, v35
    ds_write_b64 v8, v[26:27] offset:17424
    v_pk_mul_f32 v[20:21], v[32:33], v[32:33] op_sel:[1,1] op_sel_hi:[0,1] neg_lo:[1,0]
    v_pk_mul_f32 v[22:23], v[34:35], v[34:35] op_sel:[1,1] op_sel_hi:[0,1] neg_lo:[1,0]
    v_pk_fma_f32 v[28:29], v[32:33], v[32:33], v[20:21] op_sel:[0,0,0] op_sel_hi:[1,0,1]
    v_pk_fma_f32 v[30:31], v[34:35], v[34:35], v[22:23] op_sel:[0,0,0] op_sel_hi:[1,0,1]
    v_cvt_pk_bf16_f32 v24, v28, v29
    v_cvt_pk_bf16_f32 v25, v30, v31
    ds_write_b64 v8, v[24:25] offset:17952
    v_pk_mul_f32 v[20:21], v[28:29], v[32:33] op_sel:[1,1] op_sel_hi:[0,1] neg_lo:[1,0]
    v_pk_mul_f32 v[22:23], v[30:31], v[34:35] op_sel:[1,1] op_sel_hi:[0,1] neg_lo:[1,0]
    v_pk_fma_f32 v[28:29], v[28:29], v[32:33], v[20:21] op_sel:[0,0,0] op_sel_hi:[1,0,1]
    v_pk_fma_f32 v[30:31], v[30:31], v[34:35], v[22:23] op_sel:[0,0,0] op_sel_hi:[1,0,1]
    v_cvt_pk_bf16_f32 v26, v28, v29
    v_cvt_pk_bf16_f32 v27, v30, v31
    ds_write_b64 v8, v[26:27] offset:18480
    v_pk_mul_f32 v[20:21], v[28:29], v[32:33] op_sel:[1,1] op_sel_hi:[0,1] neg_lo:[1,0]
    v_pk_mul_f32 v[22:23], v[30:31], v[34:35] op_sel:[1,1] op_sel_hi:[0,1] neg_lo:[1,0]
    v_pk_fma_f32 v[28:29], v[28:29], v[32:33], v[20:21] op_sel:[0,0,0] op_sel_hi:[1,0,1]
    v_pk_fma_f32 v[30:31], v[30:31], v[34:35], v[22:23] op_sel:[0,0,0] op_sel_hi:[1,0,1]
    v_cvt_pk_bf16_f32 v24, v28, v29
    v_cvt_pk_bf16_f32 v25, v30, v31
    ds_write_b64 v8, v[24:25] offset:19008
    v_pk_mul_f32 v[20:21], v[28:29], v[32:33] op_sel:[1,1] op_sel_hi:[0,1] neg_lo:[1,0]
    v_pk_mul_f32 v[22:23], v[30:31], v[34:35] op_sel:[1,1] op_sel_hi:[0,1] neg_lo:[1,0]
    v_pk_fma_f32 v[28:29], v[28:29], v[32:33], v[20:21] op_sel:[0,0,0] op_sel_hi:[1,0,1]
    v_pk_fma_f32 v[30:31], v[30:31], v[34:35], v[22:23] op_sel:[0,0,0] op_sel_hi:[1,0,1]
    v_cvt_pk_bf16_f32 v26, v28, v29
    v_cvt_pk_bf16_f32 v27, v30, v31
    ds_write_b64 v8, v[26:27] offset:19536
    v_pk_mul_f32 v[20:21], v[28:29], v[32:33] op_sel:[1,1] op_sel_hi:[0,1] neg_lo:[1,0]
    v_pk_mul_f32 v[22:23], v[30:31], v[34:35] op_sel:[1,1] op_sel_hi:[0,1] neg_lo:[1,0]
    v_pk_fma_f32 v[28:29], v[28:29], v[32:33], v[20:21] op_sel:[0,0,0] op_sel_hi:[1,0,1]
    v_pk_fma_f32 v[30:31], v[30:31], v[34:35], v[22:23] op_sel:[0,0,0] op_sel_hi:[1,0,1]
    v_cvt_pk_bf16_f32 v24, v28, v29
    v_cvt_pk_bf16_f32 v25, v30, v31
    ds_write_b64 v8, v[24:25] offset:20064
    s_waitcnt lgkmcnt(5)
    v_pk_mul_f32 v[20:21], v[28:29], v[32:33] op_sel:[1,1] op_sel_hi:[0,1] neg_lo:[1,0]
    v_pk_mul_f32 v[22:23], v[30:31], v[34:35] op_sel:[1,1] op_sel_hi:[0,1] neg_lo:[1,0]
    v_pk_fma_f32 v[28:29], v[28:29], v[32:33], v[20:21] op_sel:[0,0,0] op_sel_hi:[1,0,1]
    v_pk_fma_f32 v[30:31], v[30:31], v[34:35], v[22:23] op_sel:[0,0,0] op_sel_hi:[1,0,1]
    v_cvt_pk_bf16_f32 v26, v28, v29
    v_cvt_pk_bf16_f32 v27, v30, v31
    ds_write_b64 v8, v[26:27] offset:20592
    v_pk_mul_f32 v[20:21], v[28:29], v[32:33] op_sel:[1,1] op_sel_hi:[0,1] neg_lo:[1,0]
    v_pk_mul_f32 v[22:23], v[30:31], v[34:35] op_sel:[1,1] op_sel_hi:[0,1] neg_lo:[1,0]
    v_pk_fma_f32 v[28:29], v[28:29], v[32:33], v[20:21] op_sel:[0,0,0] op_sel_hi:[1,0,1]
    v_pk_fma_f32 v[30:31], v[30:31], v[34:35], v[22:23] op_sel:[0,0,0] op_sel_hi:[1,0,1]
    v_cvt_pk_bf16_f32 v24, v28, v29
    v_cvt_pk_bf16_f32 v25, v30, v31
    ds_write_b64 v8, v[24:25] offset:21120
    v_pk_mul_f32 v[20:21], v[28:29], v[32:33] op_sel:[1,1] op_sel_hi:[0,1] neg_lo:[1,0]
    v_pk_mul_f32 v[22:23], v[30:31], v[34:35] op_sel:[1,1] op_sel_hi:[0,1] neg_lo:[1,0]
    v_pk_fma_f32 v[28:29], v[28:29], v[32:33], v[20:21] op_sel:[0,0,0] op_sel_hi:[1,0,1]
    v_pk_fma_f32 v[30:31], v[30:31], v[34:35], v[22:23] op_sel:[0,0,0] op_sel_hi:[1,0,1]
    v_cvt_pk_bf16_f32 v26, v28, v29
    v_cvt_pk_bf16_f32 v27, v30, v31
    ds_write_b64 v8, v[26:27] offset:21648
    v_pk_mul_f32 v[20:21], v[28:29], v[32:33] op_sel:[1,1] op_sel_hi:[0,1] neg_lo:[1,0]
    v_pk_mul_f32 v[22:23], v[30:31], v[34:35] op_sel:[1,1] op_sel_hi:[0,1] neg_lo:[1,0]
    v_pk_fma_f32 v[28:29], v[28:29], v[32:33], v[20:21] op_sel:[0,0,0] op_sel_hi:[1,0,1]
    v_pk_fma_f32 v[30:31], v[30:31], v[34:35], v[22:23] op_sel:[0,0,0] op_sel_hi:[1,0,1]
    v_cvt_pk_bf16_f32 v24, v28, v29
    v_cvt_pk_bf16_f32 v25, v30, v31
    ds_write_b64 v8, v[24:25] offset:22176
    v_pk_mul_f32 v[20:21], v[28:29], v[32:33] op_sel:[1,1] op_sel_hi:[0,1] neg_lo:[1,0]
    v_pk_mul_f32 v[22:23], v[30:31], v[34:35] op_sel:[1,1] op_sel_hi:[0,1] neg_lo:[1,0]
    v_pk_fma_f32 v[28:29], v[28:29], v[32:33], v[20:21] op_sel:[0,0,0] op_sel_hi:[1,0,1]
    v_pk_fma_f32 v[30:31], v[30:31], v[34:35], v[22:23] op_sel:[0,0,0] op_sel_hi:[1,0,1]
    v_cvt_pk_bf16_f32 v26, v28, v29
    v_cvt_pk_bf16_f32 v27, v30, v31
    ds_write_b64 v8, v[26:27] offset:22704
    v_pk_mul_f32 v[20:21], v[28:29], v[32:33] op_sel:[1,1] op_sel_hi:[0,1] neg_lo:[1,0]
    v_pk_mul_f32 v[22:23], v[30:31], v[34:35] op_sel:[1,1] op_sel_hi:[0,1] neg_lo:[1,0]
    v_pk_fma_f32 v[28:29], v[28:29], v[32:33], v[20:21] op_sel:[0,0,0] op_sel_hi:[1,0,1]
    v_pk_fma_f32 v[30:31], v[30:31], v[34:35], v[22:23] op_sel:[0,0,0] op_sel_hi:[1,0,1]
    v_cvt_pk_bf16_f32 v24, v28, v29
    v_cvt_pk_bf16_f32 v25, v30, v31
    ds_write_b64 v8, v[24:25] offset:23232
    s_waitcnt lgkmcnt(5)
    v_pk_mul_f32 v[20:21], v[28:29], v[32:33] op_sel:[1,1] op_sel_hi:[0,1] neg_lo:[1,0]
    v_pk_mul_f32 v[22:23], v[30:31], v[34:35] op_sel:[1,1] op_sel_hi:[0,1] neg_lo:[1,0]
    v_pk_fma_f32 v[28:29], v[28:29], v[32:33], v[20:21] op_sel:[0,0,0] op_sel_hi:[1,0,1]
    v_pk_fma_f32 v[30:31], v[30:31], v[34:35], v[22:23] op_sel:[0,0,0] op_sel_hi:[1,0,1]
    v_cvt_pk_bf16_f32 v26, v28, v29
    v_cvt_pk_bf16_f32 v27, v30, v31
    ds_write_b64 v8, v[26:27] offset:23760
    v_pk_mul_f32 v[20:21], v[28:29], v[32:33] op_sel:[1,1] op_sel_hi:[0,1] neg_lo:[1,0]
    v_pk_mul_f32 v[22:23], v[30:31], v[34:35] op_sel:[1,1] op_sel_hi:[0,1] neg_lo:[1,0]
    v_pk_fma_f32 v[28:29], v[28:29], v[32:33], v[20:21] op_sel:[0,0,0] op_sel_hi:[1,0,1]
    v_pk_fma_f32 v[30:31], v[30:31], v[34:35], v[22:23] op_sel:[0,0,0] op_sel_hi:[1,0,1]
    v_cvt_pk_bf16_f32 v24, v28, v29
    v_cvt_pk_bf16_f32 v25, v30, v31
    ds_write_b64 v8, v[24:25] offset:24288
    v_pk_mul_f32 v[20:21], v[28:29], v[32:33] op_sel:[1,1] op_sel_hi:[0,1] neg_lo:[1,0]
    v_pk_mul_f32 v[22:23], v[30:31], v[34:35] op_sel:[1,1] op_sel_hi:[0,1] neg_lo:[1,0]
    v_pk_fma_f32 v[28:29], v[28:29], v[32:33], v[20:21] op_sel:[0,0,0] op_sel_hi:[1,0,1]
    v_pk_fma_f32 v[30:31], v[30:31], v[34:35], v[22:23] op_sel:[0,0,0] op_sel_hi:[1,0,1]
    v_cvt_pk_bf16_f32 v26, v28, v29
    v_cvt_pk_bf16_f32 v27, v30, v31
    ds_write_b64 v8, v[26:27] offset:24816
    v_pk_mul_f32 v[20:21], v[28:29], v[32:33] op_sel:[1,1] op_sel_hi:[0,1] neg_lo:[1,0]
    v_pk_mul_f32 v[22:23], v[30:31], v[34:35] op_sel:[1,1] op_sel_hi:[0,1] neg_lo:[1,0]
    v_pk_fma_f32 v[28:29], v[28:29], v[32:33], v[20:21] op_sel:[0,0,0] op_sel_hi:[1,0,1]
    v_pk_fma_f32 v[30:31], v[30:31], v[34:35], v[22:23] op_sel:[0,0,0] op_sel_hi:[1,0,1]
    v_cvt_pk_bf16_f32 v24, v28, v29
    v_cvt_pk_bf16_f32 v25, v30, v31
    ds_write_b64 v8, v[24:25] offset:25344
    v_pk_mul_f32 v[20:21], v[28:29], v[32:33] op_sel:[1,1] op_sel_hi:[0,1] neg_lo:[1,0]
    v_pk_mul_f32 v[22:23], v[30:31], v[34:35] op_sel:[1,1] op_sel_hi:[0,1] neg_lo:[1,0]
    v_pk_fma_f32 v[28:29], v[28:29], v[32:33], v[20:21] op_sel:[0,0,0] op_sel_hi:[1,0,1]
    v_pk_fma_f32 v[30:31], v[30:31], v[34:35], v[22:23] op_sel:[0,0,0] op_sel_hi:[1,0,1]
    v_cvt_pk_bf16_f32 v26, v28, v29
    v_cvt_pk_bf16_f32 v27, v30, v31
    ds_write_b64 v8, v[26:27] offset:25872
    v_pk_mul_f32 v[20:21], v[28:29], v[32:33] op_sel:[1,1] op_sel_hi:[0,1] neg_lo:[1,0]
    v_pk_mul_f32 v[22:23], v[30:31], v[34:35] op_sel:[1,1] op_sel_hi:[0,1] neg_lo:[1,0]
    v_pk_fma_f32 v[28:29], v[28:29], v[32:33], v[20:21] op_sel:[0,0,0] op_sel_hi:[1,0,1]
    v_pk_fma_f32 v[30:31], v[30:31], v[34:35], v[22:23] op_sel:[0,0,0] op_sel_hi:[1,0,1]
    v_cvt_pk_bf16_f32 v24, v28, v29
    v_cvt_pk_bf16_f32 v25, v30, v31
    ds_write_b64 v8, v[24:25] offset:26400
    s_waitcnt lgkmcnt(5)
    v_pk_mul_f32 v[20:21], v[28:29], v[32:33] op_sel:[1,1] op_sel_hi:[0,1] neg_lo:[1,0]
    v_pk_mul_f32 v[22:23], v[30:31], v[34:35] op_sel:[1,1] op_sel_hi:[0,1] neg_lo:[1,0]
    v_pk_fma_f32 v[28:29], v[28:29], v[32:33], v[20:21] op_sel:[0,0,0] op_sel_hi:[1,0,1]
    v_pk_fma_f32 v[30:31], v[30:31], v[34:35], v[22:23] op_sel:[0,0,0] op_sel_hi:[1,0,1]
    v_cvt_pk_bf16_f32 v26, v28, v29
    v_cvt_pk_bf16_f32 v27, v30, v31
    ds_write_b64 v8, v[26:27] offset:26928
    v_pk_mul_f32 v[20:21], v[28:29], v[32:33] op_sel:[1,1] op_sel_hi:[0,1] neg_lo:[1,0]
    v_pk_mul_f32 v[22:23], v[30:31], v[34:35] op_sel:[1,1] op_sel_hi:[0,1] neg_lo:[1,0]
    v_pk_fma_f32 v[28:29], v[28:29], v[32:33], v[20:21] op_sel:[0,0,0] op_sel_hi:[1,0,1]
    v_pk_fma_f32 v[30:31], v[30:31], v[34:35], v[22:23] op_sel:[0,0,0] op_sel_hi:[1,0,1]
    v_cvt_pk_bf16_f32 v24, v28, v29
    v_cvt_pk_bf16_f32 v25, v30, v31
    ds_write_b64 v8, v[24:25] offset:27456
    v_pk_mul_f32 v[20:21], v[28:29], v[32:33] op_sel:[1,1] op_sel_hi:[0,1] neg_lo:[1,0]
    v_pk_mul_f32 v[22:23], v[30:31], v[34:35] op_sel:[1,1] op_sel_hi:[0,1] neg_lo:[1,0]
    v_pk_fma_f32 v[28:29], v[28:29], v[32:33], v[20:21] op_sel:[0,0,0] op_sel_hi:[1,0,1]
    v_pk_fma_f32 v[30:31], v[30:31], v[34:35], v[22:23] op_sel:[0,0,0] op_sel_hi:[1,0,1]
    v_cvt_pk_bf16_f32 v26, v28, v29
    v_cvt_pk_bf16_f32 v27, v30, v31
    ds_write_b64 v8, v[26:27] offset:27984
    v_pk_mul_f32 v[20:21], v[28:29], v[32:33] op_sel:[1,1] op_sel_hi:[0,1] neg_lo:[1,0]
    v_pk_mul_f32 v[22:23], v[30:31], v[34:35] op_sel:[1,1] op_sel_hi:[0,1] neg_lo:[1,0]
    v_pk_fma_f32 v[28:29], v[28:29], v[32:33], v[20:21] op_sel:[0,0,0] op_sel_hi:[1,0,1]
    v_pk_fma_f32 v[30:31], v[30:31], v[34:35], v[22:23] op_sel:[0,0,0] op_sel_hi:[1,0,1]
    v_cvt_pk_bf16_f32 v24, v28, v29
    v_cvt_pk_bf16_f32 v25, v30, v31
    ds_write_b64 v8, v[24:25] offset:28512
    v_pk_mul_f32 v[20:21], v[28:29], v[32:33] op_sel:[1,1] op_sel_hi:[0,1] neg_lo:[1,0]
    v_pk_mul_f32 v[22:23], v[30:31], v[34:35] op_sel:[1,1] op_sel_hi:[0,1] neg_lo:[1,0]
    v_pk_fma_f32 v[28:29], v[28:29], v[32:33], v[20:21] op_sel:[0,0,0] op_sel_hi:[1,0,1]
    v_pk_fma_f32 v[30:31], v[30:31], v[34:35], v[22:23] op_sel:[0,0,0] op_sel_hi:[1,0,1]
    v_cvt_pk_bf16_f32 v26, v28, v29
    v_cvt_pk_bf16_f32 v27, v30, v31
    ds_write_b64 v8, v[26:27] offset:29040
    v_pk_mul_f32 v[20:21], v[28:29], v[32:33] op_sel:[1,1] op_sel_hi:[0,1] neg_lo:[1,0]
    v_pk_mul_f32 v[22:23], v[30:31], v[34:35] op_sel:[1,1] op_sel_hi:[0,1] neg_lo:[1,0]
    v_pk_fma_f32 v[28:29], v[28:29], v[32:33], v[20:21] op_sel:[0,0,0] op_sel_hi:[1,0,1]
    v_pk_fma_f32 v[30:31], v[30:31], v[34:35], v[22:23] op_sel:[0,0,0] op_sel_hi:[1,0,1]
    v_cvt_pk_bf16_f32 v24, v28, v29
    v_cvt_pk_bf16_f32 v25, v30, v31
    ds_write_b64 v8, v[24:25] offset:29568
    s_waitcnt lgkmcnt(5)
    v_pk_mul_f32 v[20:21], v[28:29], v[32:33] op_sel:[1,1] op_sel_hi:[0,1] neg_lo:[1,0]
    v_pk_mul_f32 v[22:23], v[30:31], v[34:35] op_sel:[1,1] op_sel_hi:[0,1] neg_lo:[1,0]
    v_pk_fma_f32 v[28:29], v[28:29], v[32:33], v[20:21] op_sel:[0,0,0] op_sel_hi:[1,0,1]
    v_pk_fma_f32 v[30:31], v[30:31], v[34:35], v[22:23] op_sel:[0,0,0] op_sel_hi:[1,0,1]
    v_cvt_pk_bf16_f32 v26, v28, v29
    v_cvt_pk_bf16_f32 v27, v30, v31
    ds_write_b64 v8, v[26:27] offset:30096
    v_pk_mul_f32 v[20:21], v[28:29], v[32:33] op_sel:[1,1] op_sel_hi:[0,1] neg_lo:[1,0]
    v_pk_mul_f32 v[22:23], v[30:31], v[34:35] op_sel:[1,1] op_sel_hi:[0,1] neg_lo:[1,0]
    v_pk_fma_f32 v[28:29], v[28:29], v[32:33], v[20:21] op_sel:[0,0,0] op_sel_hi:[1,0,1]
    v_pk_fma_f32 v[30:31], v[30:31], v[34:35], v[22:23] op_sel:[0,0,0] op_sel_hi:[1,0,1]
    v_cvt_pk_bf16_f32 v24, v28, v29
    v_cvt_pk_bf16_f32 v25, v30, v31
    ds_write_b64 v8, v[24:25] offset:30624
    v_pk_mul_f32 v[20:21], v[28:29], v[32:33] op_sel:[1,1] op_sel_hi:[0,1] neg_lo:[1,0]
    v_pk_mul_f32 v[22:23], v[30:31], v[34:35] op_sel:[1,1] op_sel_hi:[0,1] neg_lo:[1,0]
    v_pk_fma_f32 v[28:29], v[28:29], v[32:33], v[20:21] op_sel:[0,0,0] op_sel_hi:[1,0,1]
    v_pk_fma_f32 v[30:31], v[30:31], v[34:35], v[22:23] op_sel:[0,0,0] op_sel_hi:[1,0,1]
    v_cvt_pk_bf16_f32 v26, v28, v29
    v_cvt_pk_bf16_f32 v27, v30, v31
    ds_write_b64 v8, v[26:27] offset:31152
    v_pk_mul_f32 v[20:21], v[28:29], v[32:33] op_sel:[1,1] op_sel_hi:[0,1] neg_lo:[1,0]
    v_pk_mul_f32 v[22:23], v[30:31], v[34:35] op_sel:[1,1] op_sel_hi:[0,1] neg_lo:[1,0]
    v_pk_fma_f32 v[28:29], v[28:29], v[32:33], v[20:21] op_sel:[0,0,0] op_sel_hi:[1,0,1]
    v_pk_fma_f32 v[30:31], v[30:31], v[34:35], v[22:23] op_sel:[0,0,0] op_sel_hi:[1,0,1]
    v_cvt_pk_bf16_f32 v24, v28, v29
    v_cvt_pk_bf16_f32 v25, v30, v31
    ds_write_b64 v8, v[24:25] offset:31680
    v_pk_mul_f32 v[20:21], v[28:29], v[32:33] op_sel:[1,1] op_sel_hi:[0,1] neg_lo:[1,0]
    v_pk_mul_f32 v[22:23], v[30:31], v[34:35] op_sel:[1,1] op_sel_hi:[0,1] neg_lo:[1,0]
    v_pk_fma_f32 v[28:29], v[28:29], v[32:33], v[20:21] op_sel:[0,0,0] op_sel_hi:[1,0,1]
    v_pk_fma_f32 v[30:31], v[30:31], v[34:35], v[22:23] op_sel:[0,0,0] op_sel_hi:[1,0,1]
    v_cvt_pk_bf16_f32 v26, v28, v29
    v_cvt_pk_bf16_f32 v27, v30, v31
    ds_write_b64 v8, v[26:27] offset:32208
    v_pk_mul_f32 v[20:21], v[28:29], v[32:33] op_sel:[1,1] op_sel_hi:[0,1] neg_lo:[1,0]
    v_pk_mul_f32 v[22:23], v[30:31], v[34:35] op_sel:[1,1] op_sel_hi:[0,1] neg_lo:[1,0]
    v_pk_fma_f32 v[28:29], v[28:29], v[32:33], v[20:21] op_sel:[0,0,0] op_sel_hi:[1,0,1]
    v_pk_fma_f32 v[30:31], v[30:31], v[34:35], v[22:23] op_sel:[0,0,0] op_sel_hi:[1,0,1]
    v_cvt_pk_bf16_f32 v24, v28, v29
    v_cvt_pk_bf16_f32 v25, v30, v31
    ds_write_b64 v8, v[24:25] offset:32736
    s_waitcnt lgkmcnt(5)
    v_pk_mul_f32 v[20:21], v[28:29], v[32:33] op_sel:[1,1] op_sel_hi:[0,1] neg_lo:[1,0]
    v_pk_mul_f32 v[22:23], v[30:31], v[34:35] op_sel:[1,1] op_sel_hi:[0,1] neg_lo:[1,0]
    v_pk_fma_f32 v[28:29], v[28:29], v[32:33], v[20:21] op_sel:[0,0,0] op_sel_hi:[1,0,1]
    v_pk_fma_f32 v[30:31], v[30:31], v[34:35], v[22:23] op_sel:[0,0,0] op_sel_hi:[1,0,1]
    v_cvt_pk_bf16_f32 v26, v28, v29
    v_cvt_pk_bf16_f32 v27, v30, v31
    ds_write_b64 v8, v[26:27] offset:33264
    s_waitcnt vmcnt(0)
    s_branch L_M_ROWS
L_M_ALPHA:
    v_mul_f32 v14, 0x43800000, v10
    v_mul_f32 v15, 0x43800000, v11
    v_mul_f32 v16, 0x43800000, v12
    v_mul_f32 v17, 0x43800000, v13
    v_exp_f32 v14, v14
    v_exp_f32 v15, v15
    v_fract_f32 v16, v16
    v_fract_f32 v17, v17
    v_cos_f32 v48, v16
    v_sin_f32 v49, v16
    v_cos_f32 v50, v17
    v_sin_f32 v51, v17
    v_mul_f32 v48, v48, v14
    v_mul_f32 v49, v49, v14
    v_mul_f32 v50, v50, v15
    v_mul_f32 v51, v51, v15
    v_add_f32 v9, v9, v9
    s_waitcnt vmcnt(0)
    v_lshlrev_b32 v28, 16, v6
    v_lshlrev_b32 v29, 16, v7
    v_and_b32 v30, s9, v6
    v_and_b32 v31, s9, v7
    v_mul_f32 v28, v28, v9
    v_mul_f32 v29, -v29, v9
    v_mul_f32 v30, v30, v9
    v_mul_f32 v31, -v31, v9
    v_cvt_pk_bf16_f32 v24, v28, v29
    v_cvt_pk_bf16_f32 v25, v30, v31
    ds_write_b64 v8, v[24:25] offset:0
    v_pk_mul_f32 v[20:21], v[28:29], v[48:49] op_sel:[1,1] op_sel_hi:[0,1] neg_lo:[1,0]
    v_pk_mul_f32 v[22:23], v[30:31], v[50:51] op_sel:[1,1] op_sel_hi:[0,1] neg_lo:[1,0]
    v_pk_fma_f32 v[52:53], v[28:29], v[48:49], v[20:21] op_sel:[0,0,0] op_sel_hi:[1,0,1]
    v_pk_fma_f32 v[54:55], v[30:31], v[50:51], v[22:23] op_sel:[0,0,0] op_sel_hi:[1,0,1]
    v_cvt_pk_bf16_f32 v26, v52, v53
    v_cvt_pk_bf16_f32 v27, v54, v55
    ds_write_b64 v8, v[26:27] offset:5808
    v_pk_mul_f32 v[20:21], v[28:29], v[32:33] op_sel:[1,1] op_sel_hi:[0,1] neg_lo:[1,0]
    v_pk_mul_f32 v[22:23], v[30:31], v[34:35] op_sel:[1,1] op_sel_hi:[0,1] neg_lo:[1,0]
    v_pk_fma_f32 v[28:29], v[28:29], v[32:33], v[20:21] op_sel:[0,0,0] op_sel_hi:[1,0,1]
    v_pk_fma_f32 v[30:31], v[30:31], v[34:35], v[22:23] op_sel:[0,0,0] op_sel_hi:[1,0,1]
    v_cvt_pk_bf16_f32 v24, v28, v29
    v_cvt_pk_bf16_f32 v25, v30, v31
    ds_write_b64 v8, v[24:25] offset:528
    v_pk_mul_f32 v[20:21], v[28:29], v[32:33] op_sel:[1,1] op_sel_hi:[0,1] neg_lo:[1,0]
    v_pk_mul_f32 v[22:23], v[30:31], v[34:35] op_sel:[1,1] op_sel_hi:[0,1] neg_lo:[1,0]
    v_pk_fma_f32 v[28:29], v[28:29], v[32:33], v[20:21] op_sel:[0,0,0] op_sel_hi:[1,0,1]
    v_pk_fma_f32 v[30:31], v[30:31], v[34:35], v[22:23] op_sel:[0,0,0] op_sel_hi:[1,0,1]
    v_cvt_pk_bf16_f32 v26, v28, v29
    v_cvt_pk_bf16_f32 v27, v30, v31
    ds_write_b64 v8, v[26:27] offset:1056
    v_pk_mul_f32 v[20:21], v[28:29], v[48:49] op_sel:[1,1] op_sel_hi:[0,1] neg_lo:[1,0]
    v_pk_mul_f32 v[22:23], v[30:31], v[50:51] op_sel:[1,1] op_sel_hi:[0,1] neg_lo:[1,0]
    v_pk_fma_f32 v[52:53], v[28:29], v[48:49], v[20:21] op_sel:[0,0,0] op_sel_hi:[1,0,1]
    v_pk_fma_f32 v[54:55], v[30:31], v[50:51], v[22:23] op_sel:[0,0,0] op_sel_hi:[1,0,1]
    v_cvt_pk_bf16_f32 v24, v52, v53
    v_cvt_pk_bf16_f32 v25, v54, v55
    ds_write_b64 v8, v[24:25] offset:6336
    v_pk_mul_f32 v[20:21], v[28:29], v[32:33] op_sel:[1,1] op_sel_hi:[0,1] neg_lo:[1,0]
    v_pk_mul_f32 v[22:23], v[30:31], v[34:35] op_sel:[1,1] op_sel_hi:[0,1] neg_lo:[1,0]
    v_pk_fma_f32 v[28:29], v[28:29], v[32:33], v[20:21] op_sel:[0,0,0] op_sel_hi:[1,0,1]
    v_pk_fma_f32 v[30:31], v[30:31], v[34:35], v[22:23] op_sel:[0,0,0] op_sel_hi:[1,0,1]
    v_cvt_pk_bf16_f32 v26, v28, v29
    v_cvt_pk_bf16_f32 v27, v30, v31
    ds_write_b64 v8, v[26:27] offset:1584
    s_waitcnt lgkmcnt(5)
    v_pk_mul_f32 v[20:21], v[28:29], v[32:33] op_sel:[1,1] op_sel_hi:[0,1] neg_lo:[1,0]
    v_pk_mul_f32 v[22:23], v[30:31], v[34:35] op_sel:[1,1] op_sel_hi:[0,1] neg_lo:[1,0]
    v_pk_fma_f32 v[28:29], v[28:29], v[32:33], v[20:21] op_sel:[0,0,0] op_sel_hi:[1,0,1]
    v_pk_fma_f32 v[30:31], v[30:31], v[34:35], v[22:23] op_sel:[0,0,0] op_sel_hi:[1,0,1]
    v_cvt_pk_bf16_f32 v24, v28, v29
    v_cvt_pk_bf16_f32 v25, v30, v31
    ds_write_b64 v8, v[24:25] offset:2112
    v_pk_mul_f32 v[20:21], v[28:29], v[48:49] op_sel:[1,1] op_sel_hi:[0,1] neg_lo:[1,0]
    v_pk_mul_f32 v[22:23], v[30:31], v[50:51] op_sel:[1,1] op_sel_hi:[0,1] neg_lo:[1,0]
    v_pk_fma_f32 v[40:41], v[28:29], v[48:49], v[20:21] op_sel:[0,0,0] op_sel_hi:[1,0,1]
    v_pk_fma_f32 v[42:43], v[30:31], v[50:51], v[22:23] op_sel:[0,0,0] op_sel_hi:[1,0,1]
    v_cvt_pk_bf16_f32 v26, v40, v41
    v_cvt_pk_bf16_f32 v27, v42, v43
    ds_write_b64 v8, v[26:27] offset:6864
    v_pk_mul_f32 v[20:21], v[28:29], v[32:33] op_sel:[1,1] op_sel_hi:[0,1] neg_lo:[1,0]
    v_pk_mul_f32 v[22:23], v[30:31], v[34:35] op_sel:[1,1] op_sel_hi:[0,1] neg_lo:[1,0]
    v_pk_fma_f32 v[28:29], v[28:29], v[32:33], v[20:21] op_sel:[0,0,0] op_sel_hi:[1,0,1]
    v_pk_fma_f32 v[30:31], v[30:31], v[34:35], v[22:23] op_sel:[0,0,0] op_sel_hi:[1,0,1]
    v_cvt_pk_bf16_f32 v24, v28, v29
    v_cvt_pk_bf16_f32 v25, v30, v31
    ds_write_b64 v8, v[24:25] offset:2640
    v_pk_mul_f32 v[20:21], v[28:29], v[32:33] op_sel:[1,1] op_sel_hi:[0,1] neg_lo:[1,0]
    v_pk_mul_f32 v[22:23], v[30:31], v[34:35] op_sel:[1,1] op_sel_hi:[0,1] neg_lo:[1,0]
    v_pk_fma_f32 v[28:29], v[28:29], v[32:33], v[20:21] op_sel:[0,0,0] op_sel_hi:[1,0,1]
    v_pk_fma_f32 v[30:31], v[30:31], v[34:35], v[22:23] op_sel:[0,0,0] op_sel_hi:[1,0,1]
    v_cvt_pk_bf16_f32 v26, v28, v29
    v_cvt_pk_bf16_f32 v27, v30, v31
    ds_write_b64 v8, v[26:27] offset:3168
    v_pk_mul_f32 v[20:21], v[28:29], v[48:49] op_sel:[1,1] op_sel_hi:[0,1] neg_lo:[1,0]
    v_pk_mul_f32 v[22:23], v[30:31], v[50:51] op_sel:[1,1] op_sel_hi:[0,1] neg_lo:[1,0]
    v_pk_fma_f32 v[52:53], v[28:29], v[48:49], v[20:21] op_sel:[0,0,0] op_sel_hi:[1,0,1]
    v_pk_fma_f32 v[54:55], v[30:31], v[50:51], v[22:23] op_sel:[0,0,0] op_sel_hi:[1,0,1]
    v_cvt_pk_bf16_f32 v24, v52, v53
    v_cvt_pk_bf16_f32 v25, v54, v55
    ds_write_b64 v8, v[24:25] offset:7392
    v_pk_mul_f32 v[20:21], v[28:29], v[32:33] op_sel:[1,1] op_sel_hi:[0,1] neg_lo:[1,0]
    v_pk_mul_f32 v[22:23], v[30:31], v[34:35] op_sel:[1,1] op_sel_hi:[0,1] neg_lo:[1,0]
    v_pk_fma_f32 v[28:29], v[28:29], v[32:33], v[20:21] op_sel:[0,0,0] op_sel_hi:[1,0,1]
    v_pk_fma_f32 v[30:31], v[30:31], v[34:35], v[22:23] op_sel:[0,0,0] op_sel_hi:[1,0,1]
    v_cvt_pk_bf16_f32 v26, v28, v29
    v_cvt_pk_bf16_f32 v27, v30, v31
    ds_write_b64 v8, v[26:27] offset:3696
    s_waitcnt lgkmcnt(5)
    v_pk_mul_f32 v[20:21], v[28:29], v[32:33] op_sel:[1,1] op_sel_hi:[0,1] neg_lo:[1,0]
    v_pk_mul_f32 v[22:23], v[30:31], v[34:35] op_sel:[1,1] op_sel_hi:[0,1] neg_lo:[1,0]
    v_pk_fma_f32 v[28:29], v[28:29], v[32:33], v[20:21] op_sel:[0,0,0] op_sel_hi:[1,0,1]
    v_pk_fma_f32 v[30:31], v[30:31], v[34:35], v[22:23] op_sel:[0,0,0] op_sel_hi:[1,0,1]
    v_cvt_pk_bf16_f32 v24, v28, v29
    v_cvt_pk_bf16_f32 v25, v30, v31
    ds_write_b64 v8, v[24:25] offset:4224
    v_pk_mul_f32 v[20:21], v[28:29], v[48:49] op_sel:[1,1] op_sel_hi:[0,1] neg_lo:[1,0]
    v_pk_mul_f32 v[22:23], v[30:31], v[50:51] op_sel:[1,1] op_sel_hi:[0,1] neg_lo:[1,0]
    v_pk_fma_f32 v[44:45], v[28:29], v[48:49], v[20:21] op_sel:[0,0,0] op_sel_hi:[1,0,1]
    v_pk_fma_f32 v[46:47], v[30:31], v[50:51], v[22:23] op_sel:[0,0,0] op_sel_hi:[1,0,1]
    v_cvt_pk_bf16_f32 v26, v44, v45
    v_cvt_pk_bf16_f32 v27, v46, v47
    ds_write_b64 v8, v[26:27] offset:7920
    v_pk_mul_f32 v[20:21], v[28:29], v[32:33] op_sel:[1,1] op_sel_hi:[0,1] neg_lo:[1,0]
    v_pk_mul_f32 v[22:23], v[30:31], v[34:35] op_sel:[1,1] op_sel_hi:[0,1] neg_lo:[1,0]
    v_pk_fma_f32 v[28:29], v[28:29], v[32:33], v[20:21] op_sel:[0,0,0] op_sel_hi:[1,0,1]
    v_pk_fma_f32 v[30:31], v[30:31], v[34:35], v[22:23] op_sel:[0,0,0] op_sel_hi:[1,0,1]
    v_cvt_pk_bf16_f32 v24, v28, v29
    v_cvt_pk_bf16_f32 v25, v30, v31
    ds_write_b64 v8, v[24:25] offset:4752
    v_pk_mul_f32 v[20:21], v[28:29], v[32:33] op_sel:[1,1] op_sel_hi:[0,1] neg_lo:[1,0]
    v_pk_mul_f32 v[22:23], v[30:31], v[34:35] op_sel:[1,1] op_sel_hi:[0,1] neg_lo:[1,0]
    v_pk_fma_f32 v[28:29], v[28:29], v[32:33], v[20:21] op_sel:[0,0,0] op_sel_hi:[1,0,1]
    v_pk_fma_f32 v[30:31], v[30:31], v[34:35], v[22:23] op_sel:[0,0,0] op_sel_hi:[1,0,1]
    v_cvt_pk_bf16_f32 v26, v28, v29
    v_cvt_pk_bf16_f32 v27, v30, v31
    ds_write_b64 v8, v[26:27] offset:5280
    v_pk_mul_f32 v[20:21], v[28:29], v[48:49] op_sel:[1,1] op_sel_hi:[0,1] neg_lo:[1,0]
    v_pk_mul_f32 v[22:23], v[30:31], v[50:51] op_sel:[1,1] op_sel_hi:[0,1] neg_lo:[1,0]
    v_pk_fma_f32 v[52:53], v[28:29], v[48:49], v[20:21] op_sel:[0,0,0] op_sel_hi:[1,0,1]
    v_pk_fma_f32 v[54:55], v[30:31], v[50:51], v[22:23] op_sel:[0,0,0] op_sel_hi:[1,0,1]
    v_cvt_pk_bf16_f32 v24, v52, v53
    v_cvt_pk_bf16_f32 v25, v54, v55
    ds_write_b64 v8, v[24:25] offset:8448
    v_pk_mul_f32 v[20:21], v[40:41], v[48:49] op_sel:[1,1] op_sel_hi:[0,1] neg_lo:[1,0]
    v_pk_mul_f32 v[22:23], v[42:43], v[50:51] op_sel:[1,1] op_sel_hi:[0,1] neg_lo:[1,0]
    v_pk_fma_f32 v[40:41], v[40:41], v[48:49], v[20:21] op_sel:[0,0,0] op_sel_hi:[1,0,1]
    v_pk_fma_f32 v[42:43], v[42:43], v[50:51], v[22:23] op_sel:[0,0,0] op_sel_hi:[1,0,1]
    v_cvt_pk_bf16_f32 v26, v40, v41
    v_cvt_pk_bf16_f32 v27, v42, v43
    ds_write_b64 v8, v[26:27] offset:8976
    s_waitcnt lgkmcnt(5)
    v_pk_mul_f32 v[20:21], v[44:45], v[48:49] op_sel:[1,1] op_sel_hi:[0,1] neg_lo:[1,0]
    v_pk_mul_f32 v[22:23], v[46:47], v[50:51] op_sel:[1,1] op_sel_hi:[0,1] neg_lo:[1,0]
    v_pk_fma_f32 v[44:45], v[44:45], v[48:49], v[20:21] op_sel:[0,0,0] op_sel_hi:[1,0,1]
    v_pk_fma_f32 v[46:47], v[46:47], v[50:51], v[22:23] op_sel:[0,0,0] op_sel_hi:[1,0,1]
    v_cvt_pk_bf16_f32 v24, v44, v45
    v_cvt_pk_bf16_f32 v25, v46, v47
    ds_write_b64 v8, v[24:25] offset:9504
    v_pk_mul_f32 v[20:21], v[40:41], v[48:49] op_sel:[1,1] op_sel_hi:[0,1] neg_lo:[1,0]
    v_pk_mul_f32 v[22:23], v[42:43], v[50:51] op_sel:[1,1] op_sel_hi:[0,1] neg_lo:[1,0]
    v_pk_fma_f32 v[40:41], v[40:41], v[48:49], v[20:21] op_sel:[0,0,0] op_sel_hi:[1,0,1]
    v_pk_fma_f32 v[42:43], v[42:43], v[50:51], v[22:23] op_sel:[0,0,0] op_sel_hi:[1,0,1]
    v_cvt_pk_bf16_f32 v26, v40, v41
    v_cvt_pk_bf16_f32 v27, v42, v43
    ds_write_b64 v8, v[26:27] offset:11088
    v_pk_mul_f32 v[20:21], v[44:45], v[48:49] op_sel:[1,1] op_sel_hi:[0,1] neg_lo:[1,0]
    v_pk_mul_f32 v[22:23], v[46:47], v[50:51] op_sel:[1,1] op_sel_hi:[0,1] neg_lo:[1,0]
    v_pk_fma_f32 v[44:45], v[44:45], v[48:49], v[20:21] op_sel:[0,0,0] op_sel_hi:[1,0,1]
    v_pk_fma_f32 v[46:47], v[46:47], v[50:51], v[22:23] op_sel:[0,0,0] op_sel_hi:[1,0,1]
    v_cvt_pk_bf16_f32 v24, v44, v45
    v_cvt_pk_bf16_f32 v25, v46, v47
    ds_write_b64 v8, v[24:25] offset:11616
    v_pk_mul_f32 v[20:21], v[44:45], v[48:49] op_sel:[1,1] op_sel_hi:[0,1] neg_lo:[1,0]
    v_pk_mul_f32 v[22:23], v[46:47], v[50:51] op_sel:[1,1] op_sel_hi:[0,1] neg_lo:[1,0]
    v_pk_fma_f32 v[44:45], v[44:45], v[48:49], v[20:21] op_sel:[0,0,0] op_sel_hi:[1,0,1]
    v_pk_fma_f32 v[46:47], v[46:47], v[50:51], v[22:23] op_sel:[0,0,0] op_sel_hi:[1,0,1]
    v_cvt_pk_bf16_f32 v26, v44, v45
    v_cvt_pk_bf16_f32 v27, v46, v47
    ds_write_b64 v8, v[26:27] offset:10032
    v_pk_mul_f32 v[20:21], v[44:45], v[48:49] op_sel:[1,1] op_sel_hi:[0,1] neg_lo:[1,0]
    v_pk_mul_f32 v[22:23], v[46:47], v[50:51] op_sel:[1,1] op_sel_hi:[0,1] neg_lo:[1,0]
    v_pk_fma_f32 v[44:45], v[44:45], v[48:49], v[20:21] op_sel:[0,0,0] op_sel_hi:[1,0,1]
    v_pk_fma_f32 v[46:47], v[46:47], v[50:51], v[22:23] op_sel:[0,0,0] op_sel_hi:[1,0,1]
    v_cvt_pk_bf16_f32 v24, v44, v45
    v_cvt_pk_bf16_f32 v25, v46, v47
    ds_write_b64 v8, v[24:25] offset:10560
    v_pk_mul_f32 v[20:21], v[44:45], v[48:49] op_sel:[1,1] op_sel_hi:[0,1] neg_lo:[1,0]
    v_pk_mul_f32 v[22:23], v[46:47], v[50:51] op_sel:[1,1] op_sel_hi:[0,1] neg_lo:[1,0]
    v_pk_fma_f32 v[44:45], v[44:45], v[48:49], v[20:21] op_sel:[0,0,0] op_sel_hi:[1,0,1]
    v_pk_fma_f32 v[46:47], v[46:47], v[50:51], v[22:23] op_sel:[0,0,0] op_sel_hi:[1,0,1]
    v_cvt_pk_bf16_f32 v26, v44, v45
    v_cvt_pk_bf16_f32 v27, v46, v47
    ds_write_b64 v8, v[26:27] offset:12144
    s_waitcnt lgkmcnt(5)
    v_pk_mul_f32 v[20:21], v[44:45], v[48:49] op_sel:[1,1] op_sel_hi:[0,1] neg_lo:[1,0]
    v_pk_mul_f32 v[22:23], v[46:47], v[50:51] op_sel:[1,1] op_sel_hi:[0,1] neg_lo:[1,0]
    v_pk_fma_f32 v[44:45], v[44:45], v[48:49], v[20:21] op_sel:[0,0,0] op_sel_hi:[1,0,1]
    v_pk_fma_f32 v[46:47], v[46:47], v[50:51], v[22:23] op_sel:[0,0,0] op_sel_hi:[1,0,1]
    v_cvt_pk_bf16_f32 v24, v44, v45
    v_cvt_pk_bf16_f32 v25, v46, v47
    ds_write_b64 v8, v[24:25] offset:12672
L_M_ROWS:
    s_lshl_b32 s74, s4, 2
    s_add_u32 s74, s74, 144320
    v_lshlrev_b32 v164, 2, v0
    v_add_u32 v164, 144624, v164
    v_mov_b32 v165, 1
    v_writelane_b32 v164, s74, 0
    s_xor_b32 s62, s74, 4
    v_mov_b32 v15, s62
    ds_write_b32 v164, v165 offset:272
    ds_read_b32 v14, v15 offset:272
    v_bfe_u32 v10, v0, 2, 3
    v_mov_b32 v11, 0x08040400
    s_mov_b32 s74, 0x15110d0b
    v_and_b32 v12, 3, v0
    v_perm_b32 v10, s74, v11, v10
    v_and_b32 v10, 0xff, v10
    v_add_u32 v10, v10, v12
    v_and_b32 v3, 31, v0
    v_lshrrev_b32 v4, 5, v0
    v_mul_u32_u24 v1, 528, v10
    v_mul_u32_u24 v2, 528, v3
    v_lshlrev_b32 v11, 4, v4
    v_add3_u32 v1, v1, v11, s63
    v_add3_u32 v2, v2, v11, s63
    s_mov_b32 s3, 1000000
    s_waitcnt lgkmcnt(0)
    v_cmp_eq_u32 vcc, 0, v14
    s_cbranch_vccnz L_M_SP1
L_M_SP1D:
    ds_read_b128 v[32:35], v1 offset:0
    ds_read_b128 v[36:39], v2 offset:16896
    ds_read_b128 v[40:43], v1 offset:32
    ds_read_b128 v[44:47], v2 offset:16928
    ds_read_b128 v[48:51], v1 offset:64
    ds_read_b128 v[52:55], v2 offset:16960
    ds_read_b128 v[56:59], v1 offset:96
    ds_read_b128 v[60:63], v2 offset:16992
    ds_read_b128 v[64:67], v1 offset:128
    ds_read_b128 v[68:71], v2 offset:17024
    ds_read_b128 v[72:75], v1 offset:160
    ds_read_b128 v[76:79], v2 offset:17056
    ds_read_b128 v[80:83], v1 offset:192
    ds_read_b128 v[84:87], v2 offset:17088
    s_mul_i32 s74, s60, 5376
    s_add_u32 s74, s74, 9216
    v_lshlrev_b32 v10, 4, v3
    v_lshl_add_u32 v11, v4, 3, v10
    v_sub_u32 v11, 568, v11
    v_add_u32 v11, s74, v11
    v_cmp_eq_u32 vcc, 63, v0
    v_bfe_u32 v92, v0, 2, 2
    v_and_b32 v93, 3, v0
    v_lshrrev_b32 v94, 4, v0
    s_waitcnt lgkmcnt(12)
    v_mfma_f32_32x32x16_bf16 v[16:31], v[32:35], v[36:39], 0
    ds_read_b128 v[32:35], v1 offset:224
    ds_read_b128 v[36:39], v2 offset:17120
    v_and_b32 v95, 15, v0
    v_mul_u32_u24 v9, 1344, v92
    s_waitcnt lgkmcnt(12)
    v_mfma_f32_32x32x16_bf16 v[16:31], v[40:43], v[44:47], v[16:31]
    ds_read_b128 v[40:43], v1 offset:256
    ds_read_b128 v[44:47], v2 offset:17152
    v_lshl_add_u32 v9, v93, 4, v9
    v_add_u32 v9, s74, v9
    s_waitcnt lgkmcnt(12)
    v_mfma_f32_32x32x16_bf16 v[16:31], v[48:51], v[52:55], v[16:31]
    ds_read_b128 v[48:51], v1 offset:288
    ds_read_b128 v[52:55], v2 offset:17184
    v_mov_b32 v96, 0
    v_mov_b32 v97, 0
    s_waitcnt lgkmcnt(12)
    v_mfma_f32_32x32x16_bf16 v[16:31], v[56:59], v[60:63], v[16:31]
    ds_read_b128 v[56:59], v1 offset:320
    ds_read_b128 v[60:63], v2 offset:17216
    v_mov_b32 v98, 0
    v_mov_b32 v99, 0
    s_waitcnt lgkmcnt(12)
    v_mfma_f32_32x32x16_bf16 v[16:31], v[64:67], v[68:71], v[16:31]
    ds_read_b128 v[64:67], v1 offset:352
    ds_read_b128 v[68:71], v2 offset:17248
    s_mul_i32 s75, s60, 1280
    s_add_u32 s75, s75, 19968
    s_waitcnt lgkmcnt(12)
    v_mfma_f32_32x32x16_bf16 v[16:31], v[72:75], v[76:79], v[16:31]
    ds_read_b128 v[72:75], v1 offset:384
    ds_read_b128 v[76:79], v2 offset:17280
    v_lshl_add_u32 v12, v0, 4, s75
    v_lshlrev_b32 v13, 2, v3
    s_waitcnt lgkmcnt(12)
    v_mfma_f32_32x32x16_bf16 v[16:31], v[80:83], v[84:87], v[16:31]
    ds_read_b128 v[80:83], v1 offset:416
    ds_read_b128 v[84:87], v2 offset:17312
    v_lshl_add_u32 v13, v4, 7, v13
    v_sub_u32 v13, 380, v13
    s_waitcnt lgkmcnt(12)
    v_mfma_f32_32x32x16_bf16 v[16:31], v[32:35], v[36:39], v[16:31]
    ds_read_b128 v[32:35], v1 offset:448
    ds_read_b128 v[36:39], v2 offset:17344
    v_add_u32 v13, s75, v13
    v_lshlrev_b32 v14, 1, v3
    s_waitcnt lgkmcnt(12)
    v_mfma_f32_32x32x16_bf16 v[16:31], v[40:43], v[44:47], v[16:31]
    ds_read_b128 v[40:43], v1 offset:480
    ds_read_b128 v[44:47], v2 offset:17376
    v_lshl_add_u32 v14, v4, 7, v14
    v_sub_u32 v14, 702, v14
    s_waitcnt lgkmcnt(12)
    v_mfma_f32_32x32x16_bf16 v[16:31], v[48:51], v[52:55], v[16:31]
    v_add_u32 v14, s75, v14
    v_mul_u32_u24 v100, 1344, v93
    v_lshl_add_u32 v100, v94, 4, v100
    v_cmp_eq_u32 s[64:65], 3, v93
    v_lshlrev_b32 v88, 3, v92
    s_waitcnt lgkmcnt(10)
    v_mfma_f32_32x32x16_bf16 v[16:31], v[56:59], v[60:63], v[16:31]
    v_add_u32 v89, 8, v88
    v_cndmask_b32 v88, v88, v89, s[64:65]
    v_sub_u32 v100, v100, v88
    s_add_u32 s74, s74, 32
    v_add_u32 v100, s74, v100
    s_waitcnt lgkmcnt(8)
    v_mfma_f32_32x32x16_bf16 v[16:31], v[64:67], v[68:71], v[16:31]
    s_mul_i32 s74, s60, 4608
    s_add_u32 s74, s74, 32
    v_lshl_add_u32 v88, v95, 1, v94
    v_lshl_add_u32 v101, v88, 4, s74
    v_lshlrev_b32 v88, 1, v94
    s_waitcnt lgkmcnt(6)
    v_mfma_f32_32x32x16_bf16 v[16:31], v[72:75], v[76:79], v[16:31]
    v_sub_u32 v88, v88, v95
    s_add_u32 s74, s75, 120
    v_lshl_add_u32 v102, v88, 3, s74
    v_lshlrev_b32 v88, 2, v94
    v_sub_u32 v88, v88, v95
    s_waitcnt lgkmcnt(4)
    v_mfma_f32_32x32x16_bf16 v[16:31], v[80:83], v[84:87], v[16:31]
    v_and_b32 v89, 1, v0
    v_mul_u32_u24 v90, 380, v89
    v_lshl_add_u32 v104, v88, 2, v90
    s_add_u32 s74, s75, 576
    v_add_u32 v104, s74, v104
    s_waitcnt lgkmcnt(2)
    v_mfma_f32_32x32x16_bf16 v[16:31], v[32:35], v[36:39], v[16:31]
    s_mul_i32 s74, s60, 11488
    s_add_u32 s74, s74, 22560
    v_lshl_add_u32 v88, v94, 3, v92
    v_and_b32 v90, 1, v92
    v_add3_u32 v91, v88, v93, -3
    s_waitcnt lgkmcnt(0)
    v_mfma_f32_32x32x16_bf16 v[16:31], v[40:43], v[44:47], v[16:31]
    v_ashrrev_i32 v103, 4, v91
    v_add_u32 v103, v103, v91
    v_add_u32 v91, 4, v91
    v_ashrrev_i32 v109, 4, v91
    v_add_u32 v109, v109, v91
    v_mul_u32_u24 v91, 3456, v90
    v_add_u32 v91, s74, v91
    v_lshl_add_u32 v103, v103, 3, v91
    v_lshl_add_u32 v109, v109, 3, v91
    v_lshlrev_b32 v88, 1, v88
    v_add3_u32 v91, v88, v93, -3
    v_ashrrev_i32 v105, 4, v91
    v_add_u32 v105, v105, v91
    v_add_u32 v91, 8, v91
    s_cmp_eq_u32 s61, 0
    s_cbranch_scc0 L_M_Y
    ds_write_b128 v9, v[96:99] offset:1088
    v_cndmask_b32 v21, v21, v20, vcc
    v_cvt_pk_bf16_f32 v32, v20, v19
    v_cvt_pk_bf16_f32 v33, v18, v17
    ds_write_b64 v11, v[32:33] offset:512
    v_cvt_pk_bf16_f32 v34, v21, v20
    v_cvt_pk_bf16_f32 v35, v19, v18
    ds_write_b64 v11, v[34:35] offset:1856
    v_cvt_pk_bf16_f32 v36, v22, v21
    v_cvt_pk_bf16_f32 v37, v20, v19
    ds_write_b64 v11, v[36:37] offset:3200
    v_cvt_pk_bf16_f32 v38, v19, v18
    v_cvt_pk_bf16_f32 v39, v17, v16
    ds_write_b64 v11, v[38:39] offset:4544
    v_cvt_pk_bf16_f32 v43, v16, 0
    v_cvt_pk_bf16_f32 v40, v17, v16
    v_cvt_pk_bf16_f32 v42, v18, v17
    v_cvt_pk_bf16_f32 v41, v29, v29
    s_mov_b64 exec, 1
    ds_write_b32 v11, v43 offset:520
    ds_write_b32 v11, v40 offset:1864
    ds_write_b64 v11, v[42:43] offset:3208
    s_mov_b64 exec, -1
    v_readlane_b32 s68, v41, 63
    ds_write_b32 v164, v165 offset:176
    v_ashrrev_i32 v110, 4, v91
    v_add_u32 v110, v110, v91
    v_mul_u32_u24 v91, 2352, v90
    s_add_u32 s74, s74, 6912
    v_add_u32 v91, s74, v91
    v_lshl_add_u32 v105, v105, 3, v91
    v_lshl_add_u32 v110, v110, 3, v91
    v_lshl_add_u32 v88, v94, 2, v95
    v_and_b32 v88, 15, v88
    v_lshl_add_u32 v88, v94, 4, v88
    s_lshl_b32 s74, s61, 10
    s_add_u32 s74, s74, s63
    v_lshl_add_u32 v106, v88, 4, s74
    v_mul_u32_u24 v166, 104, v89
    v_add_u32 v166, 144448, v166
    v_lshlrev_b32 v107, 2, v89
    v_add_u32 v107, 144448, v107
    v_mov_b32 v167, s62
    v_lshlrev_b32 v88, 3, v94
    v_sub_u32 v108, v95, v88
    v_mov_b32 v1, v100
    v_mov_b32 v2, v101
    v_mov_b32 v3, v102
    v_mov_b32 v5, v103
    v_mov_b32 v6, v104
    v_mov_b32 v7, v105
    v_mov_b32 v8, v106
    v_mov_b32 v10, v109
    v_mov_b32 v11, v110
    s_and_b32 s69, s68, 0xffff
    s_and_b32 s70, s68, 0xffff0000
    v_mov_b32 v88, s68
    v_mov_b32 v89, s69
    v_mov_b32 v90, s70
    v_cmp_eq_u32 vcc, -12, v108
    v_cmp_eq_u32 s[64:65], -13, v108
    v_cmp_eq_u32 s[66:67], -11, v108
    v_cndmask_b32 v128, 0, v88, vcc
    v_cndmask_b32 v128, v128, v89, s[64:65]
    v_cndmask_b32 v128, v128, v90, s[66:67]
    v_cmp_eq_u32 vcc, -10, v108
    v_cmp_eq_u32 s[64:65], -11, v108
    v_cmp_eq_u32 s[66:67], -9, v108
    v_cndmask_b32 v129, 0, v88, vcc
    v_cndmask_b32 v129, v129, v89, s[64:65]
    v_cndmask_b32 v129, v129, v90, s[66:67]
    v_cmp_eq_u32 vcc, -8, v108
    v_cmp_eq_u32 s[64:65], -9, v108
    v_cmp_eq_u32 s[66:67], -7, v108
    v_cndmask_b32 v130, 0, v88, vcc
    v_cndmask_b32 v130, v130, v89, s[64:65]
    v_cndmask_b32 v130, v130, v90, s[66:67]
    v_cmp_eq_u32 vcc, -6, v108
    v_cmp_eq_u32 s[64:65], -7, v108
    v_cmp_eq_u32 s[66:67], -5, v108
    v_cndmask_b32 v131, 0, v88, vcc
    v_cndmask_b32 v131, v131, v89, s[64:65]
    v_cndmask_b32 v131, v131, v90, s[66:67]
L_MX_SP2:
    s_sub_u32 s3, s3, 1
    s_cbranch_scc1 L_END
    ds_read_b32 v9, v167 offset:176
    ds_read_b32 v4, v107
    s_waitcnt lgkmcnt(0)
    v_min_u32 v9, v9, v4
    v_cmp_eq_u32 vcc, 0, v9
    s_cbranch_vccnz L_MX_SP2
    s_setprio 2
    ds_read_b64 v[12:13], v1 offset:1024
    ds_read_b64 v[14:15], v1 offset:1032
    ds_read_b128 v[16:19], v2 offset:448
    ds_read_b64 v[20:21], v1 offset:960
    ds_read_b64 v[22:23], v1 offset:968
    ds_read_b128 v[24:27], v2 offset:384
    ds_read_b64 v[28:29], v1 offset:896
    ds_read_b64 v[30:31], v1 offset:904
    ds_read_b128 v[32:35], v2 offset:320
    ds_read_b64 v[36:37], v1 offset:832
    ds_read_b64 v[38:39], v1 offset:840
    ds_read_b128 v[40:43], v2 offset:256
    ds_read_b64 v[44:45], v1 offset:512
    ds_read_b64 v[46:47], v1 offset:520
    s_waitcnt lgkmcnt(11)
    v_mfma_f32_16x16x32_bf16 v[132:135], v[12:15], v[16:19], 0
    ds_read_b64 v[48:49], v1 offset:448
    ds_read_b64 v[50:51], v1 offset:456
    ds_read_b32 v4, v166 offset:8
    s_waitcnt lgkmcnt(11)
    v_mfma_f32_16x16x32_bf16 v[132:135], v[20:23], v[24:27], v[132:135]
    ds_read_b64 v[52:53], v1 offset:384
    ds_read_b64 v[54:55], v1 offset:392
    s_waitcnt lgkmcnt(10)
    v_mfma_f32_16x16x32_bf16 v[132:135], v[28:31], v[32:35], v[132:135]
    ds_read_b64 v[56:57], v1 offset:320
    ds_read_b64 v[58:59], v1 offset:328
    s_waitcnt lgkmcnt(9)
    v_mfma_f32_16x16x32_bf16 v[132:135], v[36:39], v[40:43], v[132:135]
    ds_read_b128 v[60:63], v2 offset:960
    s_waitcnt lgkmcnt(8)
    v_mfma_f32_16x16x32_bf16 v[136:139], v[44:47], v[16:19], 0
    ds_read_b128 v[64:67], v2 offset:896
    s_waitcnt lgkmcnt(7)
    v_mfma_f32_16x16x32_bf16 v[136:139], v[48:51], v[24:27], v[136:139]
    ds_read_b128 v[68:71], v2 offset:832
    s_waitcnt lgkmcnt(5)
    v_mfma_f32_16x16x32_bf16 v[136:139], v[52:55], v[32:35], v[136:139]
    ds_read_b128 v[72:75], v2 offset:768
    v_cmp_eq_u32 vcc, 0, v4
    s_cbranch_vccnz L_MX_G2
L_MX_GOK2:
    s_waitcnt lgkmcnt(4)
    v_mfma_f32_16x16x32_bf16 v[136:139], v[56:59], v[40:43], v[136:139]
    ds_read_b128 v[76:79], v2 offset:1472
    ds_write_b128 v8, v[132:135] offset:0
    ds_write_b32 v164, v165 offset:0
    s_waitcnt lgkmcnt(6)
    v_mfma_f32_16x16x32_bf16 v[136:139], v[12:15], v[60:63], v[136:139]
    ds_read_b128 v[80:83], v2 offset:1408
    s_waitcnt lgkmcnt(6)
    v_mfma_f32_16x16x32_bf16 v[136:139], v[20:23], v[64:67], v[136:139]
    ds_read_b128 v[84:87], v2 offset:1344
    s_waitcnt lgkmcnt(6)
    v_mfma_f32_16x16x32_bf16 v[136:139], v[28:31], v[68:71], v[136:139]
    ds_read_b128 v[88:91], v2 offset:1280
    s_waitcnt lgkmcnt(6)
    v_mfma_f32_16x16x32_bf16 v[136:139], v[36:39], v[72:75], v[136:139]
    ds_read_b64 v[92:93], v1 offset:0
    ds_read_b64 v[94:95], v1 offset:8
    v_mfma_f32_16x16x32_bf16 v[140:143], v[44:47], v[60:63], 0
    ds_read_b64_tr_b16 v[96:97], v5 offset:0
    ds_read_b64_tr_b16 v[98:99], v10 offset:0
    ds_read_b32 v4, v166 offset:12
    v_mfma_f32_16x16x32_bf16 v[140:143], v[48:51], v[64:67], v[140:143]
    ds_read_b64 v[100:101], v3 offset:256
    ds_read_b64 v[102:103], v3 offset:264
    ds_write_b128 v8, v[136:139] offset:2048
    ds_write_b32 v164, v165 offset:16
    v_mfma_f32_16x16x32_bf16 v[140:143], v[52:55], v[68:71], v[140:143]
    s_waitcnt lgkmcnt(12)
    ds_read_b64 v[104:105], v3 offset:128
    ds_read_b64 v[106:107], v3 offset:136
    v_mfma_f32_16x16x32_bf16 v[140:143], v[56:59], v[72:75], v[140:143]
    v_mfma_f32_16x16x32_bf16 v[140:143], v[12:15], v[76:79], v[140:143]
    s_waitcnt lgkmcnt(11)
    v_mfma_f32_16x16x32_bf16 v[140:143], v[20:23], v[80:83], v[140:143]
    v_mfma_f32_16x16x32_bf16 v[140:143], v[28:31], v[84:87], v[140:143]
    s_waitcnt lgkmcnt(6)
    v_cmp_eq_u32 vcc, 0, v4
    s_cbranch_vccnz L_MX_G3
L_MX_GOK3:
    v_mfma_f32_16x16x32_bf16 v[140:143], v[36:39], v[88:91], v[140:143]
    ds_read_b64_tr_b16 v[108:109], v5 offset:544
    ds_read_b64_tr_b16 v[110:111], v10 offset:544
    v_mfma_f32_16x16x32_bf16 v[140:143], v[92:95], v[16:19], v[140:143]
    ds_read_b128 v[112:115], v2 offset:1984
    s_waitcnt lgkmcnt(3)
    v_mfma_f32_16x16x32_bf16 v[140:143], v[96:99], v[100:103], v[140:143]
    ds_read_b128 v[116:119], v2 offset:1920
    v_mfma_f32_16x16x32_bf16 v[144:147], v[44:47], v[76:79], 0
    ds_read_b128 v[120:123], v2 offset:1856
    v_mfma_f32_16x16x32_bf16 v[144:147], v[48:51], v[80:83], v[144:147]
    ds_read_b128 v[124:127], v2 offset:1792
    v_mfma_f32_16x16x32_bf16 v[144:147], v[52:55], v[84:87], v[144:147]
    s_nop 1
    ds_write_b128 v8, v[140:143] offset:4096
    ds_write_b32 v164, v165 offset:32
    v_mfma_f32_16x16x32_bf16 v[144:147], v[56:59], v[88:91], v[144:147]
    ds_read_b64 v[24:25], v3 offset:0
    ds_read_b64 v[26:27], v3 offset:8
    ds_read_b32 v4, v166 offset:16
    v_mfma_f32_16x16x32_bf16 v[144:147], v[92:95], v[60:63], v[144:147]
    v_mfma_f32_16x16x32_bf16 v[144:147], v[96:99], v[104:107], v[144:147]
    s_waitcnt lgkmcnt(7)
    v_mfma_f32_16x16x32_bf16 v[144:147], v[108:111], v[100:103], v[144:147]
    v_mfma_f32_16x16x32_bf16 v[144:147], v[12:15], v[112:115], v[144:147]
    v_mfma_f32_16x16x32_bf16 v[144:147], v[20:23], v[116:119], v[144:147]
    s_waitcnt lgkmcnt(3)
    v_mfma_f32_16x16x32_bf16 v[144:147], v[28:31], v[120:123], v[144:147]
    s_waitcnt lgkmcnt(0)
    v_cmp_eq_u32 vcc, 0, v4
    s_cbranch_vccnz L_MX_G4
L_MX_GOK4:
    v_mfma_f32_16x16x32_bf16 v[144:147], v[36:39], v[124:127], v[144:147]
    ds_read_b64_tr_b16 v[32:33], v5 offset:1088
    ds_read_b64_tr_b16 v[34:35], v10 offset:1088
    v_mfma_f32_16x16x32_bf16 v[148:151], v[44:47], v[112:115], 0
    ds_read_b128 v[40:43], v2 offset:2496
    v_mfma_f32_16x16x32_bf16 v[148:151], v[48:51], v[116:119], v[148:151]
    ds_read_b128 v[64:67], v2 offset:2432
    v_mfma_f32_16x16x32_bf16 v[148:151], v[52:55], v[120:123], v[148:151]
    ds_read_b128 v[68:71], v2 offset:2368
    ds_write_b128 v8, v[144:147] offset:6144
    ds_write_b32 v164, v165 offset:48
    v_mfma_f32_16x16x32_bf16 v[148:151], v[56:59], v[124:127], v[148:151]
    ds_read_b128 v[72:75], v2 offset:2304
    v_mfma_f32_16x16x32_bf16 v[148:151], v[92:95], v[76:79], v[148:151]
    v_mfma_f32_16x16x32_bf16 v[148:151], v[128:131], v[16:19], v[148:151]
    ds_read_b32 v4, v166 offset:20
    v_mfma_f32_16x16x32_bf16 v[148:151], v[96:99], v[24:27], v[148:151]
    v_mfma_f32_16x16x32_bf16 v[148:151], v[108:111], v[104:107], v[148:151]
    s_waitcnt lgkmcnt(5)
    v_mfma_f32_16x16x32_bf16 v[148:151], v[32:35], v[100:103], v[148:151]
    v_mfma_f32_16x16x32_bf16 v[148:151], v[12:15], v[40:43], v[148:151]
    v_mfma_f32_16x16x32_bf16 v[148:151], v[20:23], v[64:67], v[148:151]
    s_waitcnt lgkmcnt(1)
    v_mfma_f32_16x16x32_bf16 v[148:151], v[28:31], v[68:71], v[148:151]
    s_waitcnt lgkmcnt(0)
    v_cmp_eq_u32 vcc, 0, v4
    s_cbranch_vccnz L_MX_G5
L_MX_GOK5:
    v_mfma_f32_16x16x32_bf16 v[148:151], v[36:39], v[72:75], v[148:151]
    ds_read_b64_tr_b16 v[80:81], v5 offset:1632
    ds_read_b64_tr_b16 v[82:83], v10 offset:1632
    v_mfma_f32_16x16x32_bf16 v[152:155], v[44:47], v[40:43], 0
    ds_read_b128 v[84:87], v2 offset:3008
    v_mfma_f32_16x16x32_bf16 v[152:155], v[48:51], v[64:67], v[152:155]
    ds_read_b128 v[88:91], v2 offset:2944
    v_mfma_f32_16x16x32_bf16 v[152:155], v[52:55], v[68:71], v[152:155]
    ds_read_b128 v[116:119], v2 offset:2880
    ds_write_b128 v8, v[148:151] offset:8192
    ds_write_b32 v164, v165 offset:64
    v_mfma_f32_16x16x32_bf16 v[152:155], v[56:59], v[72:75], v[152:155]
    ds_read_b128 v[120:123], v2 offset:2816
    v_mfma_f32_16x16x32_bf16 v[152:155], v[92:95], v[112:115], v[152:155]
    v_mfma_f32_16x16x32_bf16 v[152:155], v[128:131], v[60:63], v[152:155]
    ds_read_b32 v4, v166 offset:24
    v_mfma_f32_16x16x32_bf16 v[152:155], v[108:111], v[24:27], v[152:155]
    v_mfma_f32_16x16x32_bf16 v[152:155], v[32:35], v[104:107], v[152:155]
    s_waitcnt lgkmcnt(5)
    v_mfma_f32_16x16x32_bf16 v[152:155], v[80:83], v[100:103], v[152:155]
    v_mfma_f32_16x16x32_bf16 v[152:155], v[12:15], v[84:87], v[152:155]
    v_mfma_f32_16x16x32_bf16 v[152:155], v[20:23], v[88:91], v[152:155]
    s_waitcnt lgkmcnt(1)
    v_mfma_f32_16x16x32_bf16 v[152:155], v[28:31], v[116:119], v[152:155]
    s_waitcnt lgkmcnt(0)
    v_cmp_eq_u32 vcc, 0, v4
    s_cbranch_vccnz L_MX_G6
L_MX_GOK6:
    v_mfma_f32_16x16x32_bf16 v[152:155], v[36:39], v[120:123], v[152:155]
    ds_read_b64_tr_b16 v[124:125], v5 offset:2176
    ds_read_b64_tr_b16 v[126:127], v10 offset:2176
    v_mfma_f32_16x16x32_bf16 v[156:159], v[44:47], v[84:87], 0
    ds_read_b128 v[16:19], v2 offset:3520
    v_mfma_f32_16x16x32_bf16 v[156:159], v[48:51], v[88:91], v[156:159]
    ds_read_b128 v[96:99], v2 offset:3456
    v_mfma_f32_16x16x32_bf16 v[156:159], v[52:55], v[116:119], v[156:159]
    ds_read_b128 v[64:67], v2 offset:3392
    ds_write_b128 v8, v[152:155] offset:10240
    ds_write_b32 v164, v165 offset:80
    v_mfma_f32_16x16x32_bf16 v[156:159], v[56:59], v[120:123], v[156:159]
    ds_read_b128 v[68:71], v2 offset:3328
    v_mfma_f32_16x16x32_bf16 v[156:159], v[92:95], v[40:43], v[156:159]
    v_mfma_f32_16x16x32_bf16 v[156:159], v[128:131], v[76:79], v[156:159]
    ds_read_b32 v4, v166 offset:28
    v_mfma_f32_16x16x32_bf16 v[156:159], v[32:35], v[24:27], v[156:159]
    v_mfma_f32_16x16x32_bf16 v[156:159], v[80:83], v[104:107], v[156:159]
    s_waitcnt lgkmcnt(5)
    v_mfma_f32_16x16x32_bf16 v[156:159], v[124:127], v[100:103], v[156:159]
    v_mfma_f32_16x16x32_bf16 v[156:159], v[12:15], v[16:19], v[156:159]
    v_mfma_f32_16x16x32_bf16 v[156:159], v[20:23], v[96:99], v[156:159]
    s_waitcnt lgkmcnt(1)
    v_mfma_f32_16x16x32_bf16 v[156:159], v[28:31], v[64:67], v[156:159]
    s_waitcnt lgkmcnt(0)
    v_cmp_eq_u32 vcc, 0, v4
    s_cbranch_vccnz L_MX_G7
L_MX_GOK7:
    v_mfma_f32_16x16x32_bf16 v[156:159], v[36:39], v[68:71], v[156:159]
    ds_read_b64_tr_b16 v[72:73], v5 offset:2720
    ds_read_b64_tr_b16 v[74:75], v10 offset:2720
    v_mfma_f32_16x16x32_bf16 v[160:163], v[44:47], v[16:19], 0
    ds_read_b128 v[60:63], v2 offset:4032
    v_mfma_f32_16x16x32_bf16 v[160:163], v[48:51], v[96:99], v[160:163]
    ds_read_b128 v[108:111], v2 offset:3968
    v_mfma_f32_16x16x32_bf16 v[160:163], v[52:55], v[64:67], v[160:163]
    ds_read_b128 v[88:91], v2 offset:3904
    ds_write_b128 v8, v[156:159] offset:12288
    ds_write_b32 v164, v165 offset:96
    v_mfma_f32_16x16x32_bf16 v[160:163], v[56:59], v[68:71], v[160:163]
    ds_read_b128 v[116:119], v2 offset:3840
    v_mfma_f32_16x16x32_bf16 v[160:163], v[92:95], v[84:87], v[160:163]
    v_mfma_f32_16x16x32_bf16 v[160:163], v[128:131], v[112:115], v[160:163]
    v_mfma_f32_16x16x32_bf16 v[160:163], v[80:83], v[24:27], v[160:163]
    v_mfma_f32_16x16x32_bf16 v[160:163], v[124:127], v[104:107], v[160:163]
    s_waitcnt lgkmcnt(4)
    v_mfma_f32_16x16x32_bf16 v[160:163], v[72:75], v[100:103], v[160:163]
    v_mfma_f32_16x16x32_bf16 v[160:163], v[12:15], v[60:63], v[160:163]
    v_mfma_f32_16x16x32_bf16 v[160:163], v[20:23], v[108:111], v[160:163]
    s_waitcnt lgkmcnt(0)
    v_mfma_f32_16x16x32_bf16 v[160:163], v[28:31], v[88:91], v[160:163]
    v_mfma_f32_16x16x32_bf16 v[160:163], v[36:39], v[116:119], v[160:163]
    s_nop 1
    s_nop 5
    ds_write_b128 v8, v[160:163] offset:14336
    ds_write_b32 v164, v165 offset:112
    s_endpgm
L_M_Y:
    ds_write_b128 v9, v[96:99]
    ds_write_b128 v12, v[96:99]
    ds_write_b128 v12, v[96:99] offset:256
    v_cndmask_b32 v27, v27, v26, vcc
    v_cvt_pk_bf16_f32 v32, v26, v26
    v_cvt_pk_bf16_f32 v33, v25, v24
    ds_write_b64 v11, v[32:33] offset:0
    v_cvt_pk_bf16_f32 v34, v26, v26
    v_cvt_pk_bf16_f32 v35, v26, v25
    ds_write_b64 v11, v[34:35] offset:1344
    v_cvt_pk_bf16_f32 v36, v27, v26
    v_cvt_pk_bf16_f32 v37, v26, v26
    ds_write_b64 v11, v[36:37] offset:2688
    v_cvt_pk_bf16_f32 v38, v26, v25
    v_cvt_pk_bf16_f32 v39, v24, v24
    ds_write_b64 v11, v[38:39] offset:4032
    v_cvt_pk_bf16_f32 v40, 0, v26
    v_cvt_pk_bf16_f32 v41, v26, v26
    v_cvt_pk_bf16_f32 v42, v29, v28
    v_cvt_pk_bf16_f32 v43, v30, v31
    v_subrev_u32 v10, 8, v11
    ds_write_b32 v13, v42
    s_waitcnt lgkmcnt(4)
    ds_write_b16 v14, v43 offset:68
    ds_write_b16 v14, v43 offset:448
    ds_write_b16_d16_hi v14, v43 offset:4
    ds_write_b16_d16_hi v14, v43 offset:384
    s_mov_b64 exec, vcc
    ds_write_b64 v10, v[40:41] offset:4032
    ds_write_b32 v10, v41 offset:4
    ds_write_b32 v10, v40 offset:1348
    s_mov_b64 exec, -1
    ds_write_b32 v164, v165 offset:176
    v_ashrrev_i32 v110, 4, v91
    v_add_u32 v110, v110, v91
    v_mul_u32_u24 v91, 2352, v90
    s_add_u32 s74, s74, 6912
    v_add_u32 v91, s74, v91
    v_lshl_add_u32 v105, v105, 3, v91
    v_lshl_add_u32 v110, v110, 3, v91
    v_lshl_add_u32 v88, v94, 2, v95
    v_and_b32 v88, 15, v88
    v_lshl_add_u32 v88, v94, 4, v88
    s_lshl_b32 s74, s61, 10
    s_add_u32 s74, s74, s63
    v_lshl_add_u32 v106, v88, 4, s74
    v_mul_u32_u24 v166, 104, v89
    v_add_u32 v166, 144448, v166
    v_lshlrev_b32 v107, 2, v89
    v_add_u32 v107, 144448, v107
    v_mov_b32 v167, s62
    v_lshlrev_b32 v88, 3, v94
    v_sub_u32 v108, v95, v88
    v_mov_b32 v1, v100
    v_mov_b32 v2, v101
    v_mov_b32 v3, v102
    v_mov_b32 v5, v103
    v_mov_b32 v6, v104
    v_mov_b32 v7, v105
    v_mov_b32 v8, v106
    v_mov_b32 v10, v109
    v_mov_b32 v11, v110
L_MY_SP2:
    s_sub_u32 s3, s3, 1
    s_cbranch_scc1 L_END
    ds_read_b32 v9, v167 offset:176
    ds_read_b32 v4, v107
    s_waitcnt lgkmcnt(0)
    v_min_u32 v9, v9, v4
    v_cmp_eq_u32 vcc, 0, v9
    s_cbranch_vccnz L_MY_SP2
    s_setprio 2
    ds_read_b64 v[12:13], v1 offset:768
    ds_read_b64 v[14:15], v1 offset:776
    ds_read_b128 v[16:19], v2 offset:192
    ds_read_b64 v[20:21], v1 offset:704
    ds_read_b64 v[22:23], v1 offset:712
    ds_read_b128 v[24:27], v2 offset:128
    ds_read_b64 v[28:29], v1 offset:640
    ds_read_b64 v[30:31], v1 offset:648
    ds_read_b128 v[32:35], v2 offset:64
    ds_read_b64 v[36:37], v1 offset:576
    ds_read_b64 v[38:39], v1 offset:584
    ds_read_b128 v[40:43], v2 offset:0
    ds_read_b64 v[44:45], v1 offset:256
    ds_read_b64 v[46:47], v1 offset:264
    s_waitcnt lgkmcnt(11)
    v_mfma_f32_16x16x32_bf16 v[132:135], v[12:15], v[16:19], 0
    ds_read_b64 v[48:49], v1 offset:192
    ds_read_b64 v[50:51], v1 offset:200
    ds_read_b32 v4, v166 offset:8
    s_waitcnt lgkmcnt(11)
    v_mfma_f32_16x16x32_bf16 v[132:135], v[20:23], v[24:27], v[132:135]
    ds_read_b64 v[52:53], v1 offset:128
    ds_read_b64 v[54:55], v1 offset:136
    s_waitcnt lgkmcnt(10)
    v_mfma_f32_16x16x32_bf16 v[132:135], v[28:31], v[32:35], v[132:135]
    ds_read_b64 v[56:57], v1 offset:64
    ds_read_b64 v[58:59], v1 offset:72
    s_waitcnt lgkmcnt(9)
    v_mfma_f32_16x16x32_bf16 v[132:135], v[36:39], v[40:43], v[132:135]
    ds_read_b128 v[60:63], v2 offset:704
    s_waitcnt lgkmcnt(8)
    v_mfma_f32_16x16x32_bf16 v[136:139], v[44:47], v[16:19], 0
    ds_read_b128 v[64:67], v2 offset:640
    s_waitcnt lgkmcnt(7)
    v_mfma_f32_16x16x32_bf16 v[136:139], v[48:51], v[24:27], v[136:139]
    ds_read_b128 v[68:71], v2 offset:576
    s_waitcnt lgkmcnt(5)
    v_mfma_f32_16x16x32_bf16 v[136:139], v[52:55], v[32:35], v[136:139]
    ds_read_b128 v[72:75], v2 offset:512
    v_cmp_eq_u32 vcc, 0, v4
    s_cbranch_vccnz L_MY_G2
L_MY_GOK2:
    s_waitcnt lgkmcnt(4)
    v_mfma_f32_16x16x32_bf16 v[136:139], v[56:59], v[40:43], v[136:139]
    ds_read_b128 v[76:79], v2 offset:1216
    ds_write_b128 v8, v[132:135] offset:0
    ds_write_b32 v164, v165 offset:0
    s_waitcnt lgkmcnt(6)
    v_mfma_f32_16x16x32_bf16 v[136:139], v[12:15], v[60:63], v[136:139]
    ds_read_b128 v[80:83], v2 offset:1152
    s_waitcnt lgkmcnt(6)
    v_mfma_f32_16x16x32_bf16 v[136:139], v[20:23], v[64:67], v[136:139]
    ds_read_b128 v[84:87], v2 offset:1088
    s_waitcnt lgkmcnt(6)
    v_mfma_f32_16x16x32_bf16 v[136:139], v[28:31], v[68:71], v[136:139]
    ds_read_b128 v[88:91], v2 offset:1024
    ds_read_b32 v4, v166 offset:12
    s_waitcnt lgkmcnt(7)
    v_mfma_f32_16x16x32_bf16 v[136:139], v[36:39], v[72:75], v[136:139]
    ds_read_b64_tr_b16 v[92:93], v5 offset:272
    ds_read_b64_tr_b16 v[94:95], v10 offset:272
    v_mfma_f32_16x16x32_bf16 v[140:143], v[44:47], v[60:63], 0
    ds_read_b64 v[96:97], v3 offset:320
    ds_read_b64 v[98:99], v3 offset:328
    v_mfma_f32_16x16x32_bf16 v[140:143], v[48:51], v[64:67], v[140:143]
    ds_read_b64 v[100:101], v3 offset:192
    ds_read_b64 v[102:103], v3 offset:200
    ds_write_b128 v8, v[136:139] offset:2048
    ds_write_b32 v164, v165 offset:16
    v_mfma_f32_16x16x32_bf16 v[140:143], v[52:55], v[68:71], v[140:143]
    v_mfma_f32_16x16x32_bf16 v[140:143], v[56:59], v[72:75], v[140:143]
    s_waitcnt lgkmcnt(10)
    v_mfma_f32_16x16x32_bf16 v[140:143], v[12:15], v[76:79], v[140:143]
    s_waitcnt lgkmcnt(8)
    v_cmp_eq_u32 vcc, 0, v4
    s_cbranch_vccnz L_MY_G3
L_MY_GOK3:
    v_mfma_f32_16x16x32_bf16 v[140:143], v[20:23], v[80:83], v[140:143]
    ds_read_b64_tr_b16 v[104:105], v5 offset:816
    ds_read_b64_tr_b16 v[106:107], v10 offset:816
    v_mfma_f32_16x16x32_bf16 v[140:143], v[28:31], v[84:87], v[140:143]
    ds_read_b128 v[108:111], v2 offset:1728
    v_mfma_f32_16x16x32_bf16 v[140:143], v[36:39], v[88:91], v[140:143]
    ds_read_b128 v[112:115], v2 offset:1664
    s_waitcnt lgkmcnt(4)
    v_mfma_f32_16x16x32_bf16 v[140:143], v[92:95], v[96:99], v[140:143]
    ds_read_b128 v[116:119], v2 offset:1600
    v_mfma_f32_16x16x32_bf16 v[144:147], v[44:47], v[76:79], 0
    ds_read_b128 v[120:123], v2 offset:1536
    v_mfma_f32_16x16x32_bf16 v[144:147], v[48:51], v[80:83], v[144:147]
    ds_read_b64_tr_b16 v[124:125], v7 offset:0
    ds_read_b64_tr_b16 v[126:127], v11 offset:0
    ds_read_b32 v4, v166 offset:16
    v_mfma_f32_16x16x32_bf16 v[144:147], v[52:55], v[84:87], v[144:147]
    ds_read_b64 v[16:17], v6 offset:192
    ds_read_b64 v[18:19], v6 offset:200
    ds_write_b128 v8, v[140:143] offset:4096
    ds_write_b32 v164, v165 offset:32
    v_mfma_f32_16x16x32_bf16 v[144:147], v[56:59], v[88:91], v[144:147]
    ds_read_b64 v[24:25], v3 offset:64
    ds_read_b64 v[26:27], v3 offset:72
    v_mfma_f32_16x16x32_bf16 v[144:147], v[92:95], v[100:103], v[144:147]
    s_waitcnt lgkmcnt(11)
    v_mfma_f32_16x16x32_bf16 v[144:147], v[104:107], v[96:99], v[144:147]
    v_mfma_f32_16x16x32_bf16 v[144:147], v[12:15], v[108:111], v[144:147]
    v_mfma_f32_16x16x32_bf16 v[144:147], v[20:23], v[112:115], v[144:147]
    s_waitcnt lgkmcnt(6)
    v_cmp_eq_u32 vcc, 0, v4
    s_cbranch_vccnz L_MY_G4
L_MY_GOK4:
    v_mfma_f32_16x16x32_bf16 v[144:147], v[28:31], v[116:119], v[144:147]
    ds_read_b64_tr_b16 v[32:33], v5 offset:1360
    ds_read_b64_tr_b16 v[34:35], v10 offset:1360
    v_mfma_f32_16x16x32_bf16 v[144:147], v[36:39], v[120:123], v[144:147]
    ds_read_b128 v[40:43], v2 offset:2240
    v_mfma_f32_16x16x32_bf16 v[148:151], v[44:47], v[108:111], 0
    ds_read_b128 v[60:63], v2 offset:2176
    v_mfma_f32_16x16x32_bf16 v[148:151], v[48:51], v[112:115], v[148:151]
    ds_read_b128 v[64:67], v2 offset:2112
    v_mfma_f32_16x16x32_bf16 v[148:151], v[52:55], v[116:119], v[148:151]
    ds_read_b128 v[68:71], v2 offset:2048
    v_mfma_f32_16x16x32_bf16 v[148:151], v[56:59], v[120:123], v[148:151]
    ds_read_b64_tr_b16 v[72:73], v7 offset:544
    ds_read_b64_tr_b16 v[74:75], v11 offset:544
    s_waitcnt lgkmcnt(13)
    ds_write_b128 v8, v[144:147] offset:6144
    ds_write_b32 v164, v165 offset:48
    s_waitcnt lgkmcnt(10)
    v_mfma_f32_16x16x32_bf16 v[148:151], v[124:127], v[16:19], v[148:151]
    ds_read_b64 v[76:77], v6 offset:128
    ds_read_b64 v[78:79], v6 offset:136
    ds_read_b32 v4, v166 offset:20
    v_mfma_f32_16x16x32_bf16 v[148:151], v[92:95], v[24:27], v[148:151]
    v_mfma_f32_16x16x32_bf16 v[148:151], v[104:107], v[100:103], v[148:151]
    s_waitcnt lgkmcnt(9)
    v_mfma_f32_16x16x32_bf16 v[148:151], v[32:35], v[96:99], v[148:151]
    v_mfma_f32_16x16x32_bf16 v[148:151], v[12:15], v[40:43], v[148:151]
    v_mfma_f32_16x16x32_bf16 v[148:151], v[20:23], v[60:63], v[148:151]
    s_waitcnt lgkmcnt(3)
    v_mfma_f32_16x16x32_bf16 v[148:151], v[28:31], v[64:67], v[148:151]
    s_waitcnt lgkmcnt(0)
    v_cmp_eq_u32 vcc, 0, v4
    s_cbranch_vccnz L_MY_G5
L_MY_GOK5:
    v_mfma_f32_16x16x32_bf16 v[148:151], v[36:39], v[68:71], v[148:151]
    ds_read_b64_tr_b16 v[80:81], v5 offset:1904
    ds_read_b64_tr_b16 v[82:83], v10 offset:1904
    v_mfma_f32_16x16x32_bf16 v[152:155], v[44:47], v[40:43], 0
    ds_read_b128 v[84:87], v2 offset:2752
    v_mfma_f32_16x16x32_bf16 v[152:155], v[48:51], v[60:63], v[152:155]
    ds_read_b128 v[88:91], v2 offset:2688
    v_mfma_f32_16x16x32_bf16 v[152:155], v[52:55], v[64:67], v[152:155]
    ds_read_b128 v[108:111], v2 offset:2624
    ds_write_b128 v8, v[148:151] offset:8192
    ds_write_b32 v164, v165 offset:64
    v_mfma_f32_16x16x32_bf16 v[152:155], v[56:59], v[68:71], v[152:155]
    ds_read_b128 v[112:115], v2 offset:2560
    v_mfma_f32_16x16x32_bf16 v[152:155], v[72:75], v[16:19], v[152:155]
    ds_read_b64_tr_b16 v[116:117], v7 offset:1088
    ds_read_b64_tr_b16 v[118:119], v11 offset:1088
    v_mfma_f32_16x16x32_bf16 v[152:155], v[124:127], v[76:79], v[152:155]
    ds_read_b64 v[120:121], v6 offset:64
    ds_read_b64 v[122:123], v6 offset:72
    v_mfma_f32_16x16x32_bf16 v[152:155], v[104:107], v[24:27], v[152:155]
    ds_read_b32 v4, v166 offset:24
    v_mfma_f32_16x16x32_bf16 v[152:155], v[32:35], v[100:103], v[152:155]
    s_waitcnt lgkmcnt(9)
    v_mfma_f32_16x16x32_bf16 v[152:155], v[80:83], v[96:99], v[152:155]
    v_mfma_f32_16x16x32_bf16 v[152:155], v[12:15], v[84:87], v[152:155]
    v_mfma_f32_16x16x32_bf16 v[152:155], v[20:23], v[88:91], v[152:155]
    s_waitcnt lgkmcnt(3)
    v_mfma_f32_16x16x32_bf16 v[152:155], v[28:31], v[108:111], v[152:155]
    v_mfma_f32_16x16x32_bf16 v[152:155], v[36:39], v[112:115], v[152:155]
    s_nop 1
    s_waitcnt lgkmcnt(0)
    v_cmp_eq_u32 vcc, 0, v4
    s_cbranch_vccnz L_MY_G6
L_MY_GOK6:
    v_mfma_f32_16x16x32_bf16 v[156:159], v[44:47], v[84:87], 0
    ds_read_b64_tr_b16 v[92:93], v5 offset:2448
    ds_read_b64_tr_b16 v[94:95], v10 offset:2448
    v_mfma_f32_16x16x32_bf16 v[156:159], v[48:51], v[88:91], v[156:159]
    ds_read_b128 v[40:43], v2 offset:3264
    ds_write_b128 v8, v[152:155] offset:10240
    ds_write_b32 v164, v165 offset:80
    v_mfma_f32_16x16x32_bf16 v[156:159], v[52:55], v[108:111], v[156:159]
    ds_read_b128 v[60:63], v2 offset:3200
    v_mfma_f32_16x16x32_bf16 v[156:159], v[56:59], v[112:115], v[156:159]
    ds_read_b128 v[64:67], v2 offset:3136
    v_mfma_f32_16x16x32_bf16 v[156:159], v[116:119], v[16:19], v[156:159]
    ds_read_b128 v[68:71], v2 offset:3072
    v_mfma_f32_16x16x32_bf16 v[156:159], v[72:75], v[76:79], v[156:159]
    ds_read_b64_tr_b16 v[104:105], v7 offset:1632
    ds_read_b64_tr_b16 v[106:107], v11 offset:1632
    v_mfma_f32_16x16x32_bf16 v[156:159], v[124:127], v[120:123], v[156:159]
    v_mfma_f32_16x16x32_bf16 v[156:159], v[32:35], v[24:27], v[156:159]
    ds_read_b64 v[84:85], v6 offset:0
    ds_read_b64 v[86:87], v6 offset:8
    v_mfma_f32_16x16x32_bf16 v[156:159], v[80:83], v[100:103], v[156:159]
    ds_read_b32 v4, v166 offset:28
    s_waitcnt lgkmcnt(7)
    v_mfma_f32_16x16x32_bf16 v[156:159], v[92:95], v[96:99], v[156:159]
    v_mfma_f32_16x16x32_bf16 v[156:159], v[12:15], v[40:43], v[156:159]
    v_mfma_f32_16x16x32_bf16 v[156:159], v[20:23], v[60:63], v[156:159]
    s_waitcnt lgkmcnt(3)
    v_mfma_f32_16x16x32_bf16 v[156:159], v[28:31], v[64:67], v[156:159]
    v_mfma_f32_16x16x32_bf16 v[156:159], v[36:39], v[68:71], v[156:159]
    s_nop 1
    v_mfma_f32_16x16x32_bf16 v[160:163], v[44:47], v[40:43], 0
    s_nop 1
    s_waitcnt lgkmcnt(0)
    v_cmp_eq_u32 vcc, 0, v4
    s_cbranch_vccnz L_MY_G7
L_MY_GOK7:
    v_mfma_f32_16x16x32_bf16 v[160:163], v[48:51], v[60:63], v[160:163]
    ds_read_b64_tr_b16 v[88:89], v5 offset:2992
    ds_read_b64_tr_b16 v[90:91], v10 offset:2992
    ds_write_b128 v8, v[156:159] offset:12288
    ds_write_b32 v164, v165 offset:96
    v_mfma_f32_16x16x32_bf16 v[160:163], v[52:55], v[64:67], v[160:163]
    ds_read_b128 v[108:111], v2 offset:3776
    v_mfma_f32_16x16x32_bf16 v[160:163], v[56:59], v[68:71], v[160:163]
    ds_read_b128 v[112:115], v2 offset:3712
    v_mfma_f32_16x16x32_bf16 v[160:163], v[104:107], v[16:19], v[160:163]
    ds_read_b128 v[32:35], v2 offset:3648
    v_mfma_f32_16x16x32_bf16 v[160:163], v[116:119], v[76:79], v[160:163]
    ds_read_b128 v[44:47], v2 offset:3584
    v_mfma_f32_16x16x32_bf16 v[160:163], v[72:75], v[120:123], v[160:163]
    v_mfma_f32_16x16x32_bf16 v[160:163], v[124:127], v[84:87], v[160:163]
    v_mfma_f32_16x16x32_bf16 v[160:163], v[80:83], v[24:27], v[160:163]
    v_mfma_f32_16x16x32_bf16 v[160:163], v[92:95], v[100:103], v[160:163]
    s_waitcnt lgkmcnt(2)
    v_mfma_f32_16x16x32_bf16 v[160:163], v[88:91], v[96:99], v[160:163]
    v_mfma_f32_16x16x32_bf16 v[160:163], v[12:15], v[108:111], v[160:163]
    v_mfma_f32_16x16x32_bf16 v[160:163], v[20:23], v[112:115], v[160:163]
    s_waitcnt lgkmcnt(0)
    v_mfma_f32_16x16x32_bf16 v[160:163], v[28:31], v[32:35], v[160:163]
    v_mfma_f32_16x16x32_bf16 v[160:163], v[36:39], v[44:47], v[160:163]
    s_nop 1
    s_nop 5
    ds_write_b128 v8, v[160:163] offset:14336
    ds_write_b32 v164, v165 offset:112
    s_endpgm
L_M_SP1:
    s_sub_u32 s3, s3, 1
    s_cbranch_scc1 L_END
    ds_read_b32 v14, v15 offset:272
    s_waitcnt lgkmcnt(0)
    v_cmp_eq_u32 vcc, 0, v14
    s_cbranch_vccnz L_M_SP1
    s_branch L_M_SP1D
L_MX_G2:
    s_sub_u32 s3, s3, 1
    s_cbranch_scc1 L_END
    ds_read_b32 v4, v166 offset:8
    s_waitcnt lgkmcnt(0)
    v_cmp_eq_u32 vcc, 0, v4
    s_cbranch_vccnz L_MX_G2
    s_branch L_MX_GOK2
L_MX_G3:
    s_sub_u32 s3, s3, 1
    s_cbranch_scc1 L_END
    ds_read_b32 v4, v166 offset:12
    s_waitcnt lgkmcnt(0)
    v_cmp_eq_u32 vcc, 0, v4
    s_cbranch_vccnz L_MX_G3
    s_branch L_MX_GOK3
L_MX_G4:
    s_sub_u32 s3, s3, 1
    s_cbranch_scc1 L_END
    ds_read_b32 v4, v166 offset:16
    s_waitcnt lgkmcnt(0)
    v_cmp_eq_u32 vcc, 0, v4
    s_cbranch_vccnz L_MX_G4
    s_branch L_MX_GOK4
L_MX_G5:
    s_sub_u32 s3, s3, 1
    s_cbranch_scc1 L_END
    ds_read_b32 v4, v166 offset:20
    s_waitcnt lgkmcnt(0)
    v_cmp_eq_u32 vcc, 0, v4
    s_cbranch_vccnz L_MX_G5
    s_branch L_MX_GOK5
L_MX_G6:
    s_sub_u32 s3, s3, 1
    s_cbranch_scc1 L_END
    ds_read_b32 v4, v166 offset:24
    s_waitcnt lgkmcnt(0)
    v_cmp_eq_u32 vcc, 0, v4
    s_cbranch_vccnz L_MX_G6
    s_branch L_MX_GOK6
L_MX_G7:
    s_sub_u32 s3, s3, 1
    s_cbranch_scc1 L_END
    ds_read_b32 v4, v166 offset:28
    s_waitcnt lgkmcnt(0)
    v_cmp_eq_u32 vcc, 0, v4
    s_cbranch_vccnz L_MX_G7
    s_branch L_MX_GOK7
L_MY_G2:
    s_sub_u32 s3, s3, 1
    s_cbranch_scc1 L_END
    ds_read_b32 v4, v166 offset:8
    s_waitcnt lgkmcnt(0)
    v_cmp_eq_u32 vcc, 0, v4
    s_cbranch_vccnz L_MY_G2
    s_branch L_MY_GOK2
L_MY_G3:
    s_sub_u32 s3, s3, 1
    s_cbranch_scc1 L_END
    ds_read_b32 v4, v166 offset:12
    s_waitcnt lgkmcnt(0)
    v_cmp_eq_u32 vcc, 0, v4
    s_cbranch_vccnz L_MY_G3
    s_branch L_MY_GOK3
L_MY_G4:
    s_sub_u32 s3, s3, 1
    s_cbranch_scc1 L_END
    ds_read_b32 v4, v166 offset:16
    s_waitcnt lgkmcnt(0)
    v_cmp_eq_u32 vcc, 0, v4
    s_cbranch_vccnz L_MY_G4
    s_branch L_MY_GOK4
L_MY_G5:
    s_sub_u32 s3, s3, 1
    s_cbranch_scc1 L_END
    ds_read_b32 v4, v166 offset:20
    s_waitcnt lgkmcnt(0)
    v_cmp_eq_u32 vcc, 0, v4
    s_cbranch_vccnz L_MY_G5
    s_branch L_MY_GOK5
L_MY_G6:
    s_sub_u32 s3, s3, 1
    s_cbranch_scc1 L_END
    ds_read_b32 v4, v166 offset:24
    s_waitcnt lgkmcnt(0)
    v_cmp_eq_u32 vcc, 0, v4
    s_cbranch_vccnz L_MY_G6
    s_branch L_MY_GOK6
L_MY_G7:
    s_sub_u32 s3, s3, 1
    s_cbranch_scc1 L_END
    ds_read_b32 v4, v166 offset:28
    s_waitcnt lgkmcnt(0)
    v_cmp_eq_u32 vcc, 0, v4
    s_cbranch_vccnz L_MY_G7
    s_branch L_MY_GOK7
L_E1_OA:
    s_sub_u32 s3, s3, 4
    s_cbranch_scc1 L_END
    buffer_load_dword v4, v7, s[12:15], s34 offen sc1
    s_waitcnt vmcnt(0)
    v_cmp_ne_u32 vcc, s8, v4
    s_cbranch_vccnz L_E1_OA
    s_branch L_E1_OP
L_E1_XW:
    s_sub_u32 s3, s3, 20
    s_cbranch_scc1 L_END
    s_sleep 2
    buffer_load_dword v4, v2, s[12:15], s10 offen sc1
    s_waitcnt vmcnt(0)
    v_cmp_ne_u32 vcc, s74, v4
    s_cbranch_vccnz L_E1_XW
    buffer_store_dwordx4 v[72:75], v1, s[12:15], s75 offen offset:0
    s_waitcnt vmcnt(0)
    s_mov_b64 exec, 1
    buffer_store_dword v166, off, s[12:15], s35 offset:0
    s_mov_b64 exec, -1
    s_branch L_E1_XWD
L_E1_G:
L_E1_GD0:
    s_sub_u32 s3, s3, 1
    s_cbranch_scc1 L_END
    ds_read_b32 v72, v6 offset:0
    s_waitcnt lgkmcnt(0)
    v_cmp_eq_u32 vcc, 0, v72
    s_cbranch_vccnz L_E1_GD0
    s_setprio 3
    ds_read_b128 v[8:11], v5 offset:0
    ds_read_b128 v[12:15], v5 offset:1024
    ds_read_b128 v[16:19], v5 offset:33792
    ds_read_b128 v[20:23], v5 offset:34816
    s_waitcnt lgkmcnt(2)
    v_add_f32 v64, v8, v12
    v_add_f32 v66, v9, v13
    v_add_f32 v68, v10, v14
    v_add_f32 v70, v11, v15
    v_fmac_f32 v24, v64, v56
    v_fmac_f32 v26, v66, v58
    v_fmac_f32 v28, v68, v60
    v_fmac_f32 v30, v70, v62
    s_waitcnt lgkmcnt(0)
    v_add_f32 v65, v16, v20
    v_add_f32 v67, v17, v21
    v_add_f32 v69, v18, v22
    v_add_f32 v71, v19, v23
    v_fmac_f32 v25, v65, v57
    v_fmac_f32 v27, v67, v59
    v_fmac_f32 v29, v69, v61
    v_fmac_f32 v31, v71, v63
    v_cvt_pk_bf16_f32 v72, v24, v25
    v_cvt_pk_bf16_f32 v73, v26, v27
    v_cvt_pk_bf16_f32 v74, v28, v29
    v_cvt_pk_bf16_f32 v75, v30, v31
    v_min_u32 v72, -2, v72
    v_min_u32 v73, -2, v73
    v_min_u32 v74, -2, v74
    v_min_u32 v75, -2, v75
    v_bfrev_b32 v12, 1
    v_lshl_add_u32 v13, v0, 2, 0
    v_add_u32 v14, 0, v76
    v_cmp_eq_u32 vcc, s28, v13
    v_cmp_eq_u32 s[24:25], s29, v13
    s_or_b64 vcc, vcc, s[24:25]
    v_cndmask_b32 v16, v14, v12, vcc
    v_lshl_add_u32 v13, v0, 2, 1
    v_add_u32 v14, 1024, v76
    v_cmp_eq_u32 vcc, s28, v13
    v_cmp_eq_u32 s[24:25], s29, v13
    s_or_b64 vcc, vcc, s[24:25]
    v_cndmask_b32 v17, v14, v12, vcc
    v_lshl_add_u32 v13, v0, 2, 2
    v_add_u32 v14, 2048, v76
    v_cmp_eq_u32 vcc, s28, v13
    v_cmp_eq_u32 s[24:25], s29, v13
    s_or_b64 vcc, vcc, s[24:25]
    v_cndmask_b32 v18, v14, v12, vcc
    v_lshl_add_u32 v13, v0, 2, 3
    v_add_u32 v14, 3072, v76
    v_cmp_eq_u32 vcc, s28, v13
    v_cmp_eq_u32 s[24:25], s29, v13
    s_or_b64 vcc, vcc, s[24:25]
    v_cndmask_b32 v19, v14, v12, vcc
    buffer_store_dword v72, v16, s[20:23], s30 offen
    buffer_store_dword v73, v17, s[20:23], s30 offen
    buffer_store_dword v74, v18, s[20:23], s30 offen
    buffer_store_dword v75, v19, s[20:23], s30 offen
    s_sub_u32 s28, s28, 256
    s_sub_u32 s29, s29, 256
    s_endpgm
L_E2_OA:
    s_sub_u32 s3, s3, 4
    s_cbranch_scc1 L_END
    buffer_load_dword v4, v7, s[12:15], s34 offen sc1
    s_waitcnt vmcnt(0)
    v_cmp_ne_u32 vcc, s8, v4
    s_cbranch_vccnz L_E2_OA
    s_branch L_E2_OP
L_E2_XW:
    s_sub_u32 s3, s3, 20
    s_cbranch_scc1 L_END
    s_sleep 2
    buffer_load_dword v4, v2, s[12:15], s10 offen sc1
    s_waitcnt vmcnt(0)
    v_cmp_ne_u32 vcc, s74, v4
    s_cbranch_vccnz L_E2_XW
    buffer_store_dwordx4 v[72:75], v1, s[12:15], s75 offen offset:0
    buffer_store_dwordx4 v[72:75], v1, s[12:15], s75 offen offset:1024
    s_waitcnt vmcnt(0)
    s_mov_b64 exec, 1
    buffer_store_dword v166, off, s[12:15], s35 offset:0
    buffer_store_dword v166, off, s[12:15], s35 offset:16
    s_mov_b64 exec, -1
    s_branch L_E2_XWD
L_E2_G:
L_E2_GD0:
    s_sub_u32 s3, s3, 1
    s_cbranch_scc1 L_END
    ds_read_b32 v72, v6 offset:0
    s_waitcnt lgkmcnt(0)
    v_cmp_eq_u32 vcc, 0, v72
    s_cbranch_vccnz L_E2_GD0
    s_setprio 3
    ds_read_b128 v[8:11], v5 offset:0
    ds_read_b128 v[12:15], v5 offset:1024
    ds_read_b128 v[16:19], v5 offset:33792
    ds_read_b128 v[20:23], v5 offset:34816
    s_waitcnt lgkmcnt(2)
    v_add_f32 v64, v8, v12
    v_add_f32 v66, v9, v13
    v_add_f32 v68, v10, v14
    v_add_f32 v70, v11, v15
    v_fmac_f32 v24, v64, v56
    v_fmac_f32 v26, v66, v58
    v_fmac_f32 v28, v68, v60
    v_fmac_f32 v30, v70, v62
    s_waitcnt lgkmcnt(0)
    v_add_f32 v65, v16, v20
    v_add_f32 v67, v17, v21
    v_add_f32 v69, v18, v22
    v_add_f32 v71, v19, v23
    v_fmac_f32 v25, v65, v57
    v_fmac_f32 v27, v67, v59
    v_fmac_f32 v29, v69, v61
    v_fmac_f32 v31, v71, v63
    v_cvt_pk_bf16_f32 v72, v24, v25
    v_cvt_pk_bf16_f32 v73, v26, v27
    v_cvt_pk_bf16_f32 v74, v28, v29
    v_cvt_pk_bf16_f32 v75, v30, v31
    v_min_u32 v72, -2, v72
    v_min_u32 v73, -2, v73
    v_min_u32 v74, -2, v74
    v_min_u32 v75, -2, v75
    v_bfrev_b32 v12, 1
    v_lshl_add_u32 v13, v0, 2, 0
    v_add_u32 v14, 0, v76
    v_cmp_eq_u32 vcc, s28, v13
    v_cmp_eq_u32 s[24:25], s29, v13
    s_or_b64 vcc, vcc, s[24:25]
    v_cndmask_b32 v16, v14, v12, vcc
    v_lshl_add_u32 v13, v0, 2, 1
    v_add_u32 v14, 1024, v76
    v_cmp_eq_u32 vcc, s28, v13
    v_cmp_eq_u32 s[24:25], s29, v13
    s_or_b64 vcc, vcc, s[24:25]
    v_cndmask_b32 v17, v14, v12, vcc
    v_lshl_add_u32 v13, v0, 2, 2
    v_add_u32 v14, 2048, v76
    v_cmp_eq_u32 vcc, s28, v13
    v_cmp_eq_u32 s[24:25], s29, v13
    s_or_b64 vcc, vcc, s[24:25]
    v_cndmask_b32 v18, v14, v12, vcc
    v_lshl_add_u32 v13, v0, 2, 3
    v_add_u32 v14, 3072, v76
    v_cmp_eq_u32 vcc, s28, v13
    v_cmp_eq_u32 s[24:25], s29, v13
    s_or_b64 vcc, vcc, s[24:25]
    v_cndmask_b32 v19, v14, v12, vcc
    buffer_store_dword v72, v16, s[20:23], s30 offen
    buffer_store_dword v73, v17, s[20:23], s30 offen
    buffer_store_dword v74, v18, s[20:23], s30 offen
    buffer_store_dword v75, v19, s[20:23], s30 offen
    s_sub_u32 s28, s28, 256
    s_sub_u32 s29, s29, 256
L_E2_GD1:
    s_sub_u32 s3, s3, 1
    s_cbranch_scc1 L_END
    ds_read_b32 v100, v6 offset:16
    s_waitcnt lgkmcnt(0)
    v_cmp_eq_u32 vcc, 0, v100
    s_cbranch_vccnz L_E2_GD1
    s_setprio 3
    ds_read_b128 v[8:11], v5 offset:2048
    ds_read_b128 v[12:15], v5 offset:3072
    ds_read_b128 v[16:19], v5 offset:35840
    ds_read_b128 v[20:23], v5 offset:36864
    s_waitcnt lgkmcnt(2)
    v_add_f32 v64, v8, v12
    v_add_f32 v66, v9, v13
    v_add_f32 v68, v10, v14
    v_add_f32 v70, v11, v15
    v_fmac_f32 v80, v64, v88
    v_fmac_f32 v82, v66, v90
    v_fmac_f32 v84, v68, v92
    v_fmac_f32 v86, v70, v94
    s_waitcnt lgkmcnt(0)
    v_add_f32 v65, v16, v20
    v_add_f32 v67, v17, v21
    v_add_f32 v69, v18, v22
    v_add_f32 v71, v19, v23
    v_fmac_f32 v81, v65, v89
    v_fmac_f32 v83, v67, v91
    v_fmac_f32 v85, v69, v93
    v_fmac_f32 v87, v71, v95
    v_cvt_pk_bf16_f32 v100, v80, v81
    v_cvt_pk_bf16_f32 v101, v82, v83
    v_cvt_pk_bf16_f32 v102, v84, v85
    v_cvt_pk_bf16_f32 v103, v86, v87
    v_min_u32 v100, -2, v100
    v_min_u32 v101, -2, v101
    v_min_u32 v102, -2, v102
    v_min_u32 v103, -2, v103
    v_bfrev_b32 v12, 1
    v_lshl_add_u32 v13, v0, 2, 0
    v_add_u32 v14, 0, v76
    v_cmp_eq_u32 vcc, s28, v13
    v_cmp_eq_u32 s[24:25], s29, v13
    s_or_b64 vcc, vcc, s[24:25]
    v_cndmask_b32 v16, v14, v12, vcc
    v_lshl_add_u32 v13, v0, 2, 1
    v_add_u32 v14, 1024, v76
    v_cmp_eq_u32 vcc, s28, v13
    v_cmp_eq_u32 s[24:25], s29, v13
    s_or_b64 vcc, vcc, s[24:25]
    v_cndmask_b32 v17, v14, v12, vcc
    v_lshl_add_u32 v13, v0, 2, 2
    v_add_u32 v14, 2048, v76
    v_cmp_eq_u32 vcc, s28, v13
    v_cmp_eq_u32 s[24:25], s29, v13
    s_or_b64 vcc, vcc, s[24:25]
    v_cndmask_b32 v18, v14, v12, vcc
    v_lshl_add_u32 v13, v0, 2, 3
    v_add_u32 v14, 3072, v76
    v_cmp_eq_u32 vcc, s28, v13
    v_cmp_eq_u32 s[24:25], s29, v13
    s_or_b64 vcc, vcc, s[24:25]
    v_cndmask_b32 v19, v14, v12, vcc
    buffer_store_dword v100, v16, s[20:23], s33 offen
    buffer_store_dword v101, v17, s[20:23], s33 offen
    buffer_store_dword v102, v18, s[20:23], s33 offen
    buffer_store_dword v103, v19, s[20:23], s33 offen
    s_sub_u32 s28, s28, 256
    s_sub_u32 s29, s29, 256
    s_endpgm
L_END:
    s_endpgm
L_CODE_END:
.section .rodata,"a"
.p2align 6
.amdhsa_kernel recurrent_scan__ssm_conv_s4d__moe_arch_mod__prompt_kernel
  .amdhsa_next_free_vgpr 168
  .amdhsa_next_free_sgpr 80
  .amdhsa_accum_offset 168
  .amdhsa_group_segment_fixed_size 0
  .amdhsa_kernarg_size 120
  .amdhsa_user_sgpr_count 2
  .amdhsa_user_sgpr_kernarg_segment_ptr 1
  .amdhsa_system_sgpr_workgroup_id_x 1
.end_amdhsa_kernel
```
